```python
import torch

def _softmax(x, axis=-1):
    return torch.softmax(x, dim=axis)
def _gelu(x):
    return torch.nn.functional.gelu(x, approximate="tanh")
def _silu(x):
    return torch.nn.functional.silu(x)
def _sigmoid(x):
    return torch.sigmoid(x)
def _layernorm(x, axis=-1, eps=1e-5):
    m = x.mean(dim=axis, keepdim=True)
    v = x.var(dim=axis, keepdim=True, unbiased=False)
    return (x - m) / torch.sqrt(v + eps)
def _scatter_add(tgt, idx, src, axis=0):
    return tgt.clone().index_add_(axis, idx, src)
def _segment_sum(src, seg, n):
    out = torch.zeros((n,) + src.shape[1:], dtype=src.dtype)
    return out.index_add_(0, seg, src)
def _pad(x, pw):
    flat = tuple(v for pair in reversed(pw) for v in pair)
    return torch.nn.functional.pad(x, flat)

kernel_name = 'interleave_layers__softmax_full_mha__moe_arch_mod__prompt'

def setup_inputs():

    _w = (lambda a: (lambda t: t.to(torch.bfloat16) if t.is_floating_point() else t)(torch.as_tensor(a)))
    def _A_setup():
        B, S, D = 1, 2048, 512
        return {
            "x": _w((lambda *s: torch.randn(*s, dtype=torch.bfloat16) * 0.05)(B, S, D)),
            "wqkv": _w((lambda *s: torch.randn(*s, dtype=torch.bfloat16) * 0.05)(D, 3 * D)),
            "wo": _w((lambda *s: torch.randn(*s, dtype=torch.bfloat16) * 0.05)(D, D)),
        }
    _A_in = _A_setup()

    def _B_setup():
        B, S, D, F, C = 1, 2048, 512, 1792, 1
        return {
            "x": _w((lambda *s: torch.randn(*s, dtype=torch.bfloat16) * 0.05)(B, S, D)),
            "w_r": _w((lambda *s: torch.randn(*s, dtype=torch.bfloat16) * 0.05)(D)),
            "w_gate": _w((lambda *s: torch.randn(*s, dtype=torch.bfloat16) * 0.05)(D, F)),
            "w_up": _w((lambda *s: torch.randn(*s, dtype=torch.bfloat16) * 0.05)(D, F)),
            "w_down": _w((lambda *s: torch.randn(*s, dtype=torch.bfloat16) * 0.05)(F, D)),
        }
    _B_in = _B_setup()

    return {
        "A_x": _A_in["x"],
        "A_wqkv": _A_in["wqkv"],
        "A_wo": _A_in["wo"],
        "B_x": _B_in["x"],
        "B_w_r": _B_in["w_r"],
        "B_w_gate": _B_in["w_gate"],
        "B_w_up": _B_in["w_up"],
        "B_w_down": _B_in["w_down"],
    }

def reference(A_x, A_wqkv, A_wo, B_x, B_w_r, B_w_gate, B_w_up, B_w_down):
    def _A_ref(x, wqkv, wo):
        B, S, D = x.shape
        H = 32; Dh = D // H
        qkv = (lambda x, *d: x.permute(*d))((x @ wqkv).reshape(B, S, 3, H, Dh), 2, 0, 3, 1, 4)
        q, k, v = qkv[0], qkv[1], qkv[2]
        scale = Dh ** -0.5
        scores = torch.einsum("bhqd,bhkd->bhqk", q, k) * scale
        p = _softmax(scores, axis=-1)
        o = torch.einsum("bhqk,bhkd->bhqd", p, v)
        return (lambda x, *d: x.permute(*d))(o, 0, 2, 1, 3).reshape(B, S, D) @ wo

    def _B_ref(x, w_r, w_gate, w_up, w_down):
        B, S, D = x.shape
        C = 1
        r = x @ w_r
        idx = torch.argsort(-r, axis=-1)[:, :C]
        idx_e = (lambda x, n, axis: torch.repeat_interleave(x, n, dim=axis))(idx.reshape(B, C, 1), D, axis=2)
        x_sel = (lambda x, i, axis: torch.take_along_dim(x, i, dim=axis))(x, idx_e, axis=1)
        g = _silu(x_sel @ w_gate)
        u = x_sel @ w_up
        y = (g * u) @ w_down
        r_sel = _sigmoid((lambda x, i, axis: torch.take_along_dim(x, i, dim=axis))(r, idx, axis=1))
        y = y * r_sel.reshape(B, C, 1)
        b_off = (torch.arange(B) * S).reshape(B, 1)
        flat_idx = (idx + b_off).reshape(B * C)
        zero = (x * 0.0).reshape(B * S, D)
        upd = _scatter_add(zero, flat_idx, y.reshape(B * C, D), axis=0)
        return x + upd.reshape(B, S, D)

    x = A_x
    x = x + _A_ref(_layernorm(x, axis=-1), A_wqkv, A_wo)
    x = x + _B_ref(_layernorm(x, axis=-1), B_w_r, B_w_gate, B_w_up, B_w_down)
    x = x + _A_ref(_layernorm(x, axis=-1), A_wqkv, A_wo)
    x = x + _B_ref(_layernorm(x, axis=-1), B_w_r, B_w_gate, B_w_up, B_w_down)
    return x
```

```asm
; @launch grid=(256,1,1) block=(512,1,1) lds=163840
.amdgcn_target "amdgcn-amd-amdhsa--gfx950"
.text
.globl interleave_layers__softmax_full_mha__moe_arch_mod__prompt_kernel
.p2align 8
.type interleave_layers__softmax_full_mha__moe_arch_mod__prompt_kernel,@function
interleave_layers__softmax_full_mha__moe_arch_mod__prompt_kernel:
    s_cmp_ge_u32 s2, 256
    s_cbranch_scc1 L_exit
    s_load_dwordx4 s[40:43], s[0:1], 0
    s_load_dwordx2 s[44:45], s[0:1], 16
    s_load_dwordx8 s[76:83], s[0:1], 32
    s_load_dwordx2 s[48:49], s[0:1], 64
    s_load_dwordx2 s[50:51], s[0:1], 80
    s_load_dwordx2 s[88:89], s[0:1], 72
    s_memrealtime s[62:63]
    v_and_b32 v1, 63, v0
    v_lshrrev_b32 v2, 6, v0
    v_lshlrev_b32 v4, 4, v1
    v_readfirstlane_b32 s6, v2
    s_and_b32 s5, s2, 7
    s_lshr_b32 s4, s2, 3
    s_lshl_b32 s5, s5, 1
    s_lshr_b32 s52, s4, 4
    s_add_u32 s5, s5, s52
    s_and_b32 s4, s4, 15
    s_mov_b32 s7, 0
    s_lshr_b32 s71, s5, 1
    s_add_u32 s71, s71, s4
    s_and_b32 s52, s6, 3
    s_lshr_b32 s53, s6, 2
    s_lshl_b32 s54, s5, 2
    s_add_u32 s54, s54, s52
    s_lshl_b32 s54, s54, 15
    s_lshl_b32 s55, s53, 9
    s_add_u32 s54, s54, s55
    v_lshrrev_b32 v2, 3, v1
    v_lshlrev_b32 v2, 10, v2
    v_and_b32 v3, 7, v1
    v_lshl_add_u32 v6, v3, 4, v2
    s_waitcnt lgkmcnt(0)
    v_mov_b32 v238, 0
    s_or_b32 s55, s2, s6
    s_cmp_lg_u32 s55, 0
    s_cbranch_scc1 L_notag
    s_mul_i32 s62, s62, 2654435769
    s_or_b32 s62, s62, 1
    v_mov_b32 v239, s62
    s_mov_b64 exec, 1
    global_store_dword v238, v239, s[88:89] sc1
    s_mov_b64 exec, -1
L_notag:
    s_mov_b32 s8, s40
    s_and_b32 s9, s41, 0xffff
    s_mov_b32 s10, 2097152
    s_mov_b32 s11, 0x00020000
    s_mov_b32 s12, s42
    s_and_b32 s13, s43, 0xffff
    s_mov_b32 s14, 1572864
    s_mov_b32 s15, 0x00020000
    s_cmp_lg_u32 s6, 7
    s_cbranch_scc1 L_nowarm
    s_lshr_b32 s55, s2, 3
    s_mul_i32 s55, s55, 49152
    s_sub_u32 s56, 384, s42
    s_and_b32 s56, s56, 0x380
    s_add_u32 s55, s55, s56
    v_lshlrev_b32 v2, 10, v1
    s_mov_b32 s56, -1
    s_mov_b32 s57, 0xffff
    s_mov_b64 exec, s[56:57]
    buffer_load_dword v160, v2, s[12:15], s55 offen
    s_mov_b64 exec, -1
L_nowarm:
    v_lshrrev_b32 v2, 2, v1
    v_mul_u32_u24 v2, 3072, v2
    v_and_b32 v3, 3, v1
    v_lshl_add_u32 v5, v3, 4, v2
    s_lshl_b32 s56, s53, 4
    s_add_u32 s56, s56, s52
    s_mul_i32 s46, s56, 49152
    s_lshl_b32 s55, s4, 6
    s_add_u32 s46, s46, s55
    s_mul_i32 s47, s53, 49152
    s_lshl_b32 s55, s52, 10
    s_add_u32 s47, s47, s55
    v_bfe_u32 v3, v1, 4, 2
    v_lshlrev_b32 v3, 4, v3
    v_xor_b32 v6, v6, v3
    v_xor_b32 v7, 64, v6
    s_lshl_b32 s61, s6, 14
    s_add_u32 s55, s71, 0
    s_and_b32 s55, s55, 3
    s_lshl_b32 s55, s55, 7
    s_add_u32 s55, s55, s54
    s_add_u32 m0, s61, 0
    s_nop 0
    buffer_load_dwordx4 v6, s[8:11], s55 offen lds
    s_add_u32 s55, s55, 0x2000
    s_add_u32 m0, s61, 1024
    s_nop 0
    buffer_load_dwordx4 v7, s[8:11], s55 offen lds
    s_add_u32 s55, s55, 0x2000
    s_add_u32 m0, s61, 2048
    s_nop 0
    buffer_load_dwordx4 v6, s[8:11], s55 offen lds
    s_add_u32 s55, s55, 0x2000
    s_add_u32 m0, s61, 3072
    s_nop 0
    buffer_load_dwordx4 v7, s[8:11], s55 offen lds
    s_cmp_lg_u32 s6, 6
    s_cbranch_scc1 L_noxw
    s_xor_b32 s55, s2, 4
    s_and_b32 s56, s55, 7
    s_lshl_b32 s56, s56, 18
    s_lshr_b32 s55, s55, 3
    s_lshl_b32 s55, s55, 13
    s_add_u32 s55, s55, s56
    v_lshlrev_b32 v2, 7, v1
    buffer_load_dword v161, v2, s[8:11], s55 offen
L_noxw:
    s_add_u32 s55, s71, 1
    s_and_b32 s55, s55, 3
    s_lshl_b32 s55, s55, 7
    s_add_u32 s55, s55, s54
    s_add_u32 m0, s61, 4096
    s_nop 0
    buffer_load_dwordx4 v6, s[8:11], s55 offen lds
    s_add_u32 s55, s55, 0x2000
    s_add_u32 m0, s61, 5120
    s_nop 0
    buffer_load_dwordx4 v7, s[8:11], s55 offen lds
    s_add_u32 s55, s55, 0x2000
    s_add_u32 m0, s61, 6144
    s_nop 0
    buffer_load_dwordx4 v6, s[8:11], s55 offen lds
    s_add_u32 s55, s55, 0x2000
    s_add_u32 m0, s61, 7168
    s_nop 0
    buffer_load_dwordx4 v7, s[8:11], s55 offen lds
    s_mov_b32 s16, s50
    s_and_b32 s17, s51, 0xffff
    s_mov_b32 s18, 23068672
    s_mov_b32 s19, 0x00020000
    s_mov_b32 s20, s44
    s_and_b32 s21, s45, 0xffff
    s_mov_b32 s22, 524288
    s_mov_b32 s23, 0x00020000
    s_mov_b32 s24, s48
    s_and_b32 s25, s49, 0xffff
    s_mov_b32 s26, 2097152
    s_mov_b32 s27, 0x00020000
    s_mov_b32 s56, s76
    s_and_b32 s57, s77, 0xffff
    s_mov_b32 s58, 1024
    s_mov_b32 s59, 0x00020000
    s_mov_b32 s68, s82
    s_and_b32 s69, s83, 0xffff
    s_mov_b32 s36, 0
    s_mov_b32 s37, 0
    s_mov_b32 s38, 0
    s_mov_b32 s29, 0
    s_mov_b32 s32, 0x0000ffff
    s_mov_b32 s33, 0x0000ffff
    s_mov_b32 s34, 1065369472
    v_and_b32 v2, 31, v1
    v_bfe_u32 v3, v1, 1, 3
    v_lshrrev_b32 v8, 5, v1
    v_xor_b32 v3, v3, v8
    v_lshlrev_b32 v3, 4, v3
    v_lshl_add_u32 v3, v2, 7, v3
    v_add_u32 v172, s61, v3
    v_xor_b32 v173, 32, v172
    v_xor_b32 v174, 64, v172
    v_xor_b32 v175, 0x60, v172
    v_mov_b32 v164, 0
    v_mov_b32 v165, 0
    v_mov_b32 v178, 0
    v_mov_b32 v179, 0
    v_mov_b32 v166, 0
    v_mov_b32 v167, 0
    v_mov_b32 v168, 0
    v_mov_b32 v180, 161792
    v_mov_b32 v181, 1
    s_lshl_b32 s55, s53, 4
    v_add_u32 v182, s55, v180
    s_lshl_b32 s55, s53, 2
    v_add_u32 v184, s55, v180
    s_add_u32 s62, s71, s53
    v_lshl_add_u32 v2, v1, 2, v180
    ds_write_b32 v2, v179
    s_add_u32 s55, s71, 2
    s_and_b32 s55, s55, 3
    s_lshl_b32 s55, s55, 7
    s_add_u32 s55, s55, s54
    s_add_u32 m0, s61, 8192
    s_nop 0
    buffer_load_dwordx4 v6, s[8:11], s55 offen lds
    s_add_u32 s55, s55, 0x2000
    s_add_u32 m0, s61, 9216
    s_nop 0
    buffer_load_dwordx4 v7, s[8:11], s55 offen lds
    s_add_u32 s55, s55, 0x2000
    s_add_u32 m0, s61, 10240
    s_nop 0
    buffer_load_dwordx4 v6, s[8:11], s55 offen lds
    s_add_u32 s55, s55, 0x2000
    s_add_u32 m0, s61, 11264
    s_nop 0
    buffer_load_dwordx4 v7, s[8:11], s55 offen lds
    s_lshl_b32 s84, s5, 1
    s_lshr_b32 s52, s4, 3
    s_add_u32 s84, s84, s52
    s_and_b32 s53, s4, 7
    s_lshl_b32 s31, s53, 5
    s_add_u32 s31, s31, s84
    s_cmp_lt_u32 s31, 112
    s_cselect_b32 s30, 1, 0
    s_cmp_ge_u32 s53, 4
    s_cselect_b32 s31, s84, s31
    s_cselect_b32 s30, 3, s30
    s_sub_u32 s52, s53, 5
    s_cmp_lt_u32 s52, 2
    s_cselect_b32 s30, 2, s30
    s_cmp_eq_u32 s30, 2
    s_cselect_b32 s76, s82, s78
    s_cselect_b32 s77, s83, s79
    s_cselect_b32 s80, s82, s80
    s_cselect_b32 s81, s83, s81
    s_mov_b32 s101, 3584
    s_cselect_b32 s101, 1024, s101
    s_cselect_b32 s52, 229376, 229376
    s_cmp_eq_u32 s30, 3
    s_cselect_b32 s76, s42, s76
    s_cselect_b32 s77, s43, s77
    s_cselect_b32 s80, s42, s80
    s_cselect_b32 s81, s43, s81
    s_cselect_b32 s101, 3072, s101
    s_cselect_b32 s52, 196608, s52
    s_mov_b32 s78, 1835008
    s_cselect_b32 s78, 1572864, s78
    s_cmp_eq_u32 s30, 0
    s_cselect_b32 s78, 0, s78
    s_and_b32 s77, s77, 0xffff
    s_and_b32 s81, s81, 0xffff
    s_mov_b32 s79, 0x00020000
    s_mov_b32 s82, s78
    s_mov_b32 s83, 0x00020000
    s_mul_i32 s52, s52, s6
    s_lshl_b32 s53, s31, 5
    s_add_u32 s94, s52, s53
    s_cmp_eq_u32 s30, 2
    s_cselect_b32 s52, 32768, 0
    s_cmp_eq_u32 s30, 3
    s_cselect_b32 s52, 1024, s52
    s_add_u32 s95, s94, s52
    s_cmp_eq_u32 s30, 2
    s_mov_b32 s52, 114688
    s_cselect_b32 s52, 65536, s52
    s_cmp_eq_u32 s30, 3
    s_cselect_b32 s52, 2048, s52
    s_add_u32 s96, s94, s52
    s_cmp_eq_u32 s30, 2
    s_mov_b32 s52, 114688
    s_cselect_b32 s52, 98304, s52
    s_cmp_eq_u32 s30, 3
    s_cselect_b32 s52, 98304, s52
    s_add_u32 s97, s94, s52
    s_cmp_eq_u32 s30, 2
    s_mov_b32 s52, 1073741824
    s_cselect_b32 s52, 131072, s52
    s_cmp_eq_u32 s30, 3
    s_cselect_b32 s52, 99328, s52
    s_add_u32 s98, s94, s52
    s_cmp_eq_u32 s30, 2
    s_mov_b32 s52, 1073741824
    s_cselect_b32 s52, 163840, s52
    s_cmp_eq_u32 s30, 3
    s_cselect_b32 s52, 100352, s52
    s_add_u32 s99, s94, s52
    s_cmp_eq_u32 s30, 2
    s_mov_b32 s52, 1073741824
    s_cselect_b32 s52, 196608, s52
    s_cmp_eq_u32 s30, 3
    s_cselect_b32 s52, 1073741824, s52
    s_add_u32 s100, s94, s52
    s_add_u32 s55, s71, 3
    s_and_b32 s55, s55, 3
    s_lshl_b32 s55, s55, 7
    s_add_u32 s55, s55, s54
    s_add_u32 m0, s61, 12288
    s_nop 0
    buffer_load_dwordx4 v6, s[8:11], s55 offen lds
    s_add_u32 s55, s55, 0x2000
    s_add_u32 m0, s61, 13312
    s_nop 0
    buffer_load_dwordx4 v7, s[8:11], s55 offen lds
    s_add_u32 s55, s55, 0x2000
    s_add_u32 m0, s61, 14336
    s_nop 0
    buffer_load_dwordx4 v6, s[8:11], s55 offen lds
    s_add_u32 s55, s55, 0x2000
    s_add_u32 m0, s61, 15360
    s_nop 0
    buffer_load_dwordx4 v7, s[8:11], s55 offen lds
    s_call_b64 s[90:91], L_gsetup
    s_waitcnt vmcnt(0) lgkmcnt(0)
    ds_read_b128 v[16:19], v172 offset:0
    ds_read_b128 v[20:23], v173 offset:0
    ds_read_b128 v[24:27], v174 offset:0
    ds_read_b128 v[28:31], v175 offset:0
    ds_read_b128 v[32:35], v172 offset:4096
    ds_read_b128 v[36:39], v173 offset:4096
    ds_read_b128 v[40:43], v174 offset:4096
    ds_read_b128 v[44:47], v175 offset:4096
    ds_read_b128 v[48:51], v172 offset:8192
    ds_read_b128 v[52:55], v173 offset:8192
    ds_read_b128 v[56:59], v174 offset:8192
    ds_read_b128 v[60:63], v175 offset:8192
    ds_read_b128 v[64:67], v172 offset:12288
    ds_read_b128 v[68:71], v173 offset:12288
    ds_read_b128 v[72:75], v174 offset:12288
    ds_read_b128 v[76:79], v175 offset:12288
    s_waitcnt lgkmcnt(0)
    s_barrier
    s_add_u32 s60, s71, 0
    s_and_b32 s60, s60, 3
    s_mul_i32 s55, s60, 196608
    s_add_u32 s55, s55, s46
    s_lshl_b32 s60, s60, 12
    s_add_u32 s60, s60, s47
    s_add_u32 m0, s60, 0
    s_nop 0
    buffer_load_dwordx4 v5, s[12:15], s55 offen offset:0 lds
    s_add_u32 m0, s60, 15360
    s_nop 0
    buffer_load_dwordx4 v5, s[12:15], s55 offen offset:1024 lds
    s_add_u32 m0, s60, 30720
    s_nop 0
    buffer_load_dwordx4 v5, s[12:15], s55 offen offset:2048 lds
    s_add_u32 s60, s71, 1
    s_and_b32 s60, s60, 3
    s_mul_i32 s55, s60, 196608
    s_add_u32 s55, s55, s46
    s_lshl_b32 s60, s60, 12
    s_add_u32 s60, s60, s47
    s_add_u32 m0, s60, 0
    s_nop 0
    buffer_load_dwordx4 v5, s[12:15], s55 offen offset:0 lds
    s_add_u32 m0, s60, 15360
    s_nop 0
    buffer_load_dwordx4 v5, s[12:15], s55 offen offset:1024 lds
    s_add_u32 m0, s60, 30720
    s_nop 0
    buffer_load_dwordx4 v5, s[12:15], s55 offen offset:2048 lds
    v_dot2c_f32_bf16 v164, s34, v16
    v_dot2c_f32_bf16 v165, v16, v16
    v_dot2c_f32_bf16 v178, s34, v17
    v_dot2c_f32_bf16 v179, v17, v17
    v_dot2c_f32_bf16 v164, s34, v18
    v_dot2c_f32_bf16 v165, v18, v18
    v_dot2c_f32_bf16 v178, s34, v19
    v_dot2c_f32_bf16 v179, v19, v19
    v_dot2c_f32_bf16 v164, s34, v20
    v_dot2c_f32_bf16 v165, v20, v20
    v_dot2c_f32_bf16 v178, s34, v21
    v_dot2c_f32_bf16 v179, v21, v21
    v_dot2c_f32_bf16 v164, s34, v22
    v_dot2c_f32_bf16 v165, v22, v22
    v_dot2c_f32_bf16 v178, s34, v23
    v_dot2c_f32_bf16 v179, v23, v23
    v_dot2c_f32_bf16 v164, s34, v24
    v_dot2c_f32_bf16 v165, v24, v24
    v_dot2c_f32_bf16 v178, s34, v25
    v_dot2c_f32_bf16 v179, v25, v25
    v_dot2c_f32_bf16 v164, s34, v26
    v_dot2c_f32_bf16 v165, v26, v26
    v_dot2c_f32_bf16 v178, s34, v27
    v_dot2c_f32_bf16 v179, v27, v27
    v_dot2c_f32_bf16 v164, s34, v28
    v_dot2c_f32_bf16 v165, v28, v28
    v_dot2c_f32_bf16 v178, s34, v29
    v_dot2c_f32_bf16 v179, v29, v29
    v_dot2c_f32_bf16 v164, s34, v30
    v_dot2c_f32_bf16 v165, v30, v30
    v_dot2c_f32_bf16 v178, s34, v31
    v_dot2c_f32_bf16 v179, v31, v31
    v_dot2c_f32_bf16 v164, s34, v32
    v_dot2c_f32_bf16 v165, v32, v32
    v_dot2c_f32_bf16 v178, s34, v33
    v_dot2c_f32_bf16 v179, v33, v33
    v_dot2c_f32_bf16 v164, s34, v34
    v_dot2c_f32_bf16 v165, v34, v34
    v_dot2c_f32_bf16 v178, s34, v35
    v_dot2c_f32_bf16 v179, v35, v35
    v_dot2c_f32_bf16 v164, s34, v36
    v_dot2c_f32_bf16 v165, v36, v36
    v_dot2c_f32_bf16 v178, s34, v37
    v_dot2c_f32_bf16 v179, v37, v37
    v_dot2c_f32_bf16 v164, s34, v38
    v_dot2c_f32_bf16 v165, v38, v38
    v_dot2c_f32_bf16 v178, s34, v39
    v_dot2c_f32_bf16 v179, v39, v39
    v_dot2c_f32_bf16 v164, s34, v40
    v_dot2c_f32_bf16 v165, v40, v40
    v_dot2c_f32_bf16 v178, s34, v41
    v_dot2c_f32_bf16 v179, v41, v41
    v_dot2c_f32_bf16 v164, s34, v42
    v_dot2c_f32_bf16 v165, v42, v42
    v_dot2c_f32_bf16 v178, s34, v43
    v_dot2c_f32_bf16 v179, v43, v43
    v_dot2c_f32_bf16 v164, s34, v44
    v_dot2c_f32_bf16 v165, v44, v44
    v_dot2c_f32_bf16 v178, s34, v45
    v_dot2c_f32_bf16 v179, v45, v45
    v_dot2c_f32_bf16 v164, s34, v46
    v_dot2c_f32_bf16 v165, v46, v46
    v_dot2c_f32_bf16 v178, s34, v47
    v_dot2c_f32_bf16 v179, v47, v47
    v_dot2c_f32_bf16 v164, s34, v48
    v_dot2c_f32_bf16 v165, v48, v48
    v_dot2c_f32_bf16 v178, s34, v49
    v_dot2c_f32_bf16 v179, v49, v49
    v_dot2c_f32_bf16 v164, s34, v50
    v_dot2c_f32_bf16 v165, v50, v50
    v_dot2c_f32_bf16 v178, s34, v51
    v_dot2c_f32_bf16 v179, v51, v51
    v_dot2c_f32_bf16 v164, s34, v52
    v_dot2c_f32_bf16 v165, v52, v52
    v_dot2c_f32_bf16 v178, s34, v53
    v_dot2c_f32_bf16 v179, v53, v53
    v_dot2c_f32_bf16 v164, s34, v54
    v_dot2c_f32_bf16 v165, v54, v54
    v_dot2c_f32_bf16 v178, s34, v55
    v_dot2c_f32_bf16 v179, v55, v55
    v_dot2c_f32_bf16 v164, s34, v56
    v_dot2c_f32_bf16 v165, v56, v56
    v_dot2c_f32_bf16 v178, s34, v57
    v_dot2c_f32_bf16 v179, v57, v57
    v_dot2c_f32_bf16 v164, s34, v58
    v_dot2c_f32_bf16 v165, v58, v58
    v_dot2c_f32_bf16 v178, s34, v59
    v_dot2c_f32_bf16 v179, v59, v59
    v_dot2c_f32_bf16 v164, s34, v60
    v_dot2c_f32_bf16 v165, v60, v60
    v_dot2c_f32_bf16 v178, s34, v61
    v_dot2c_f32_bf16 v179, v61, v61
    v_dot2c_f32_bf16 v164, s34, v62
    v_dot2c_f32_bf16 v165, v62, v62
    v_dot2c_f32_bf16 v178, s34, v63
    v_dot2c_f32_bf16 v179, v63, v63
    v_dot2c_f32_bf16 v164, s34, v64
    v_dot2c_f32_bf16 v165, v64, v64
    v_dot2c_f32_bf16 v178, s34, v65
    v_dot2c_f32_bf16 v179, v65, v65
    v_dot2c_f32_bf16 v164, s34, v66
    v_dot2c_f32_bf16 v165, v66, v66
    v_dot2c_f32_bf16 v178, s34, v67
    v_dot2c_f32_bf16 v179, v67, v67
    v_dot2c_f32_bf16 v164, s34, v68
    v_dot2c_f32_bf16 v165, v68, v68
    v_dot2c_f32_bf16 v178, s34, v69
    v_dot2c_f32_bf16 v179, v69, v69
    v_dot2c_f32_bf16 v164, s34, v70
    v_dot2c_f32_bf16 v165, v70, v70
    v_dot2c_f32_bf16 v178, s34, v71
    v_dot2c_f32_bf16 v179, v71, v71
    v_dot2c_f32_bf16 v164, s34, v72
    v_dot2c_f32_bf16 v165, v72, v72
    v_dot2c_f32_bf16 v178, s34, v73
    v_dot2c_f32_bf16 v179, v73, v73
    v_dot2c_f32_bf16 v164, s34, v74
    v_dot2c_f32_bf16 v165, v74, v74
    v_dot2c_f32_bf16 v178, s34, v75
    v_dot2c_f32_bf16 v179, v75, v75
    v_dot2c_f32_bf16 v164, s34, v76
    v_dot2c_f32_bf16 v165, v76, v76
    v_dot2c_f32_bf16 v178, s34, v77
    v_dot2c_f32_bf16 v179, v77, v77
    v_dot2c_f32_bf16 v164, s34, v78
    v_dot2c_f32_bf16 v165, v78, v78
    v_dot2c_f32_bf16 v178, s34, v79
    v_dot2c_f32_bf16 v179, v79, v79
    s_nop 1
    v_add_f32 v164, v164, v178
    v_add_f32 v165, v165, v179
    v_mov_b32 v178, v164
    v_mov_b32 v179, v165
    s_nop 0
    v_permlane32_swap_b32 v164, v178
    v_permlane32_swap_b32 v165, v179
    v_add_f32 v164, v164, v178
    v_add_f32 v165, v165, v179
    s_lshl_b32 s54, s52, 9
    s_lshl_b32 s55, s53, 3
    s_add_u32 s54, s54, s55
    s_add_u32 s54, s54, 150528
    v_and_b32 v2, 31, v1
    v_lshl_add_u32 v2, v2, 4, s54
    ds_write_b64 v2, v[164:165]
    s_lshl_b32 s54, s52, 2
    v_add_u32 v2, s54, v180
    s_mov_b64 exec, 1
    ds_add_u32 v2, v181 offset:32
    s_mov_b64 exec, -1
    s_waitcnt vmcnt(3)
    s_mov_b64 exec, 1
    ds_add_u32 v182, v181 offset:0
    s_mov_b64 exec, -1
    s_mov_b32 s63, 200000
L_interleave_layers__softmax_full_mha__moe_arch_mod__prompt_sp_1:
    ds_read_b32 v183, v182 offset:0
    s_waitcnt lgkmcnt(0)
    v_readfirstlane_b32 s60, v183
    s_nop 0
    s_cmp_ge_u32 s60, 4
    s_cbranch_scc1 L_interleave_layers__softmax_full_mha__moe_arch_mod__prompt_spd_2
    s_sleep 1
    s_sub_u32 s63, s63, 1
    s_cmp_lg_u32 s63, 0
    s_cbranch_scc1 L_interleave_layers__softmax_full_mha__moe_arch_mod__prompt_sp_1
L_interleave_layers__softmax_full_mha__moe_arch_mod__prompt_spd_2:
    ds_read_b64_tr_b16 v[128:129], v8 offset:0
    ds_read_b64_tr_b16 v[130:131], v9 offset:0
    ds_read_b64_tr_b16 v[132:133], v8 offset:16384
    ds_read_b64_tr_b16 v[134:135], v9 offset:16384
    ds_read_b64_tr_b16 v[136:137], v8 offset:32768
    ds_read_b64_tr_b16 v[138:139], v9 offset:32768
    ds_read_b64_tr_b16 v[140:141], v8 offset:1024
    ds_read_b64_tr_b16 v[142:143], v9 offset:1024
    ds_read_b64_tr_b16 v[144:145], v8 offset:17408
    ds_read_b64_tr_b16 v[146:147], v9 offset:17408
    ds_read_b64_tr_b16 v[148:149], v8 offset:33792
    ds_read_b64_tr_b16 v[150:151], v9 offset:33792
    ds_read_b64_tr_b16 v[152:153], v8 offset:2048
    ds_read_b64_tr_b16 v[154:155], v9 offset:2048
    ds_read_b64_tr_b16 v[156:157], v8 offset:18432
    ds_read_b64_tr_b16 v[158:159], v9 offset:18432
    ds_read_b64_tr_b16 v[160:161], v8 offset:34816
    ds_read_b64_tr_b16 v[162:163], v9 offset:34816
    s_waitcnt lgkmcnt(12)
    v_mfma_f32_32x32x16_bf16 v[80:95], v[128:131], v[16:19], 0
    v_mfma_f32_32x32x16_bf16 v[96:111], v[132:135], v[16:19], 0
    v_mfma_f32_32x32x16_bf16 v[112:127], v[16:19], v[136:139], 0
    s_waitcnt vmcnt(0)
    s_mov_b64 exec, 1
    ds_add_u32 v182, v181 offset:4
    s_mov_b64 exec, -1
    s_add_u32 s60, s71, 2
    s_and_b32 s60, s60, 3
    s_mul_i32 s55, s60, 196608
    s_add_u32 s55, s55, s46
    s_lshl_b32 s60, s60, 12
    s_add_u32 s60, s60, s47
    s_add_u32 m0, s60, 0
    s_nop 0
    buffer_load_dwordx4 v5, s[12:15], s55 offen offset:0 lds
    s_add_u32 m0, s60, 15360
    s_nop 0
    buffer_load_dwordx4 v5, s[12:15], s55 offen offset:1024 lds
    s_add_u32 m0, s60, 30720
    s_nop 0
    buffer_load_dwordx4 v5, s[12:15], s55 offen offset:2048 lds
    s_cmp_lg_u32 s52, 0
    s_cbranch_scc1 L_interleave_layers__softmax_full_mha__moe_arch_mod__prompt_cs_3
    v_dot2c_f32_bf16 v166, s34, v128
    v_dot2c_f32_bf16 v167, s34, v132
    v_dot2c_f32_bf16 v168, s34, v136
    v_dot2c_f32_bf16 v166, s34, v129
    v_dot2c_f32_bf16 v167, s34, v133
    v_dot2c_f32_bf16 v168, s34, v137
    v_dot2c_f32_bf16 v166, s34, v130
    v_dot2c_f32_bf16 v167, s34, v134
    v_dot2c_f32_bf16 v168, s34, v138
    v_dot2c_f32_bf16 v166, s34, v131
    v_dot2c_f32_bf16 v167, s34, v135
    v_dot2c_f32_bf16 v168, s34, v139
L_interleave_layers__softmax_full_mha__moe_arch_mod__prompt_cs_3:
    ds_read_b32 v185, v182 offset:4
    ds_read_b64_tr_b16 v[128:129], v8 offset:3072
    ds_read_b64_tr_b16 v[130:131], v9 offset:3072
    ds_read_b64_tr_b16 v[132:133], v8 offset:19456
    ds_read_b64_tr_b16 v[134:135], v9 offset:19456
    ds_read_b64_tr_b16 v[136:137], v8 offset:35840
    ds_read_b64_tr_b16 v[138:139], v9 offset:35840
    s_waitcnt lgkmcnt(12)
    v_mfma_f32_32x32x16_bf16 v[80:95], v[140:143], v[20:23], v[80:95]
    v_mfma_f32_32x32x16_bf16 v[96:111], v[144:147], v[20:23], v[96:111]
    v_mfma_f32_32x32x16_bf16 v[112:127], v[20:23], v[148:151], v[112:127]
    s_cmp_lg_u32 s52, 1
    s_cbranch_scc1 L_interleave_layers__softmax_full_mha__moe_arch_mod__prompt_cs_4
    v_dot2c_f32_bf16 v166, s34, v140
    v_dot2c_f32_bf16 v167, s34, v144
    v_dot2c_f32_bf16 v168, s34, v148
    v_dot2c_f32_bf16 v166, s34, v141
    v_dot2c_f32_bf16 v167, s34, v145
    v_dot2c_f32_bf16 v168, s34, v149
    v_dot2c_f32_bf16 v166, s34, v142
    v_dot2c_f32_bf16 v167, s34, v146
    v_dot2c_f32_bf16 v168, s34, v150
    v_dot2c_f32_bf16 v166, s34, v143
    v_dot2c_f32_bf16 v167, s34, v147
    v_dot2c_f32_bf16 v168, s34, v151
L_interleave_layers__softmax_full_mha__moe_arch_mod__prompt_cs_4:
    s_waitcnt lgkmcnt(6)
    v_readfirstlane_b32 s60, v185
    s_nop 0
    s_cmp_ge_u32 s60, 4
    s_cbranch_scc1 L_interleave_layers__softmax_full_mha__moe_arch_mod__prompt_rdy_5
    s_mov_b32 s63, 200000
L_interleave_layers__softmax_full_mha__moe_arch_mod__prompt_sp_6:
    ds_read_b32 v183, v182 offset:4
    s_waitcnt lgkmcnt(0)
    v_readfirstlane_b32 s60, v183
    s_nop 0
    s_cmp_ge_u32 s60, 4
    s_cbranch_scc1 L_interleave_layers__softmax_full_mha__moe_arch_mod__prompt_spd_7
    s_sleep 1
    s_sub_u32 s63, s63, 1
    s_cmp_lg_u32 s63, 0
    s_cbranch_scc1 L_interleave_layers__softmax_full_mha__moe_arch_mod__prompt_sp_6
L_interleave_layers__softmax_full_mha__moe_arch_mod__prompt_spd_7:
L_interleave_layers__softmax_full_mha__moe_arch_mod__prompt_rdy_5:
    ds_read_b64_tr_b16 v[140:141], v10 offset:0
    ds_read_b64_tr_b16 v[142:143], v11 offset:0
    ds_read_b64_tr_b16 v[144:145], v10 offset:16384
    ds_read_b64_tr_b16 v[146:147], v11 offset:16384
    ds_read_b64_tr_b16 v[148:149], v10 offset:32768
    ds_read_b64_tr_b16 v[150:151], v11 offset:32768
    s_waitcnt lgkmcnt(12)
    v_mfma_f32_32x32x16_bf16 v[80:95], v[152:155], v[24:27], v[80:95]
    v_mfma_f32_32x32x16_bf16 v[96:111], v[156:159], v[24:27], v[96:111]
    v_mfma_f32_32x32x16_bf16 v[112:127], v[24:27], v[160:163], v[112:127]
    s_cmp_lg_u32 s52, 2
    s_cbranch_scc1 L_interleave_layers__softmax_full_mha__moe_arch_mod__prompt_cs_8
    v_dot2c_f32_bf16 v166, s34, v152
    v_dot2c_f32_bf16 v167, s34, v156
    v_dot2c_f32_bf16 v168, s34, v160
    v_dot2c_f32_bf16 v166, s34, v153
    v_dot2c_f32_bf16 v167, s34, v157
    v_dot2c_f32_bf16 v168, s34, v161
    v_dot2c_f32_bf16 v166, s34, v154
    v_dot2c_f32_bf16 v167, s34, v158
    v_dot2c_f32_bf16 v168, s34, v162
    v_dot2c_f32_bf16 v166, s34, v155
    v_dot2c_f32_bf16 v167, s34, v159
    v_dot2c_f32_bf16 v168, s34, v163
L_interleave_layers__softmax_full_mha__moe_arch_mod__prompt_cs_8:
    ds_read_b64_tr_b16 v[152:153], v10 offset:1024
    ds_read_b64_tr_b16 v[154:155], v11 offset:1024
    ds_read_b64_tr_b16 v[156:157], v10 offset:17408
    ds_read_b64_tr_b16 v[158:159], v11 offset:17408
    ds_read_b64_tr_b16 v[160:161], v10 offset:33792
    ds_read_b64_tr_b16 v[162:163], v11 offset:33792
    s_waitcnt lgkmcnt(12)
    v_mfma_f32_32x32x16_bf16 v[80:95], v[128:131], v[28:31], v[80:95]
    v_mfma_f32_32x32x16_bf16 v[96:111], v[132:135], v[28:31], v[96:111]
    v_mfma_f32_32x32x16_bf16 v[112:127], v[28:31], v[136:139], v[112:127]
    s_cmp_lg_u32 s53, 0
    s_cbranch_scc1 L_interleave_layers__softmax_full_mha__moe_arch_mod__prompt_p0_9
    s_lshl_b32 s54, s52, 2
    v_add_u32 v2, s54, v180
    s_mov_b32 s63, 200000
L_interleave_layers__softmax_full_mha__moe_arch_mod__prompt_sp_10:
    ds_read_b32 v183, v2 offset:32
    s_waitcnt lgkmcnt(0)
    v_readfirstlane_b32 s60, v183
    s_nop 0
    s_cmp_ge_u32 s60, 2
    s_cbranch_scc1 L_interleave_layers__softmax_full_mha__moe_arch_mod__prompt_spd_11
    s_sleep 1
    s_sub_u32 s63, s63, 1
    s_cmp_lg_u32 s63, 0
    s_cbranch_scc1 L_interleave_layers__softmax_full_mha__moe_arch_mod__prompt_sp_10
L_interleave_layers__softmax_full_mha__moe_arch_mod__prompt_spd_11:
    s_lshl_b32 s54, s52, 9
    s_add_u32 s54, s54, 150528
    v_and_b32 v3, 31, v1
    v_lshl_add_u32 v2, v3, 4, s54
    ds_read_b128 v[176:179], v2
    s_lshl_b32 s54, s52, 7
    s_add_u32 s54, s54, 152576
    v_lshl_add_u32 v2, v3, 2, s54
    s_waitcnt lgkmcnt(0)
    v_add_f32 v176, v176, v178
    v_add_f32 v177, v177, v179
    v_mul_f32 v176, 0x3b000000, v176
    v_mul_f32 v177, 0x3b000000, v177
    v_fma_f32 v177, -v176, v176, v177
    v_max_f32 v177, 0, v177
    v_cvt_pk_bf16_f32 v178, v176, v177
    v_and_b32 v186, 0xffff0000, v178
    v_lshlrev_b32 v178, 16, v178
    v_add_f32 v186, 925353388, v186
    v_cvt_pk_bf16_f32 v186, v186, v186
    v_and_b32 v186, 0xffff0000, v186
    v_sqrt_f32 v186, v186
    s_nop 0
    v_cvt_pk_bf16_f32 v186, v186, v186
    v_and_b32 v186, 0xffff0000, v186
    v_rcp_f32 v179, v186
    s_nop 0
    v_mul_f32 v178, v178, v179
    ds_write_b32 v2, v179
    ds_write_b32 v2, v178 offset:512
L_interleave_layers__softmax_full_mha__moe_arch_mod__prompt_p0_9:
    s_cmp_lg_u32 s52, 3
    s_cbranch_scc1 L_interleave_layers__softmax_full_mha__moe_arch_mod__prompt_cs_12
    v_dot2c_f32_bf16 v166, s34, v128
    v_dot2c_f32_bf16 v167, s34, v132
    v_dot2c_f32_bf16 v168, s34, v136
    v_dot2c_f32_bf16 v166, s34, v129
    v_dot2c_f32_bf16 v167, s34, v133
    v_dot2c_f32_bf16 v168, s34, v137
    v_dot2c_f32_bf16 v166, s34, v130
    v_dot2c_f32_bf16 v167, s34, v134
    v_dot2c_f32_bf16 v168, s34, v138
    v_dot2c_f32_bf16 v166, s34, v131
    v_dot2c_f32_bf16 v167, s34, v135
    v_dot2c_f32_bf16 v168, s34, v139
L_interleave_layers__softmax_full_mha__moe_arch_mod__prompt_cs_12:
    ds_read_b64_tr_b16 v[128:129], v10 offset:2048
    ds_read_b64_tr_b16 v[130:131], v11 offset:2048
    ds_read_b64_tr_b16 v[132:133], v10 offset:18432
    ds_read_b64_tr_b16 v[134:135], v11 offset:18432
    ds_read_b64_tr_b16 v[136:137], v10 offset:34816
    ds_read_b64_tr_b16 v[138:139], v11 offset:34816
    s_waitcnt lgkmcnt(12)
    v_mfma_f32_32x32x16_bf16 v[80:95], v[140:143], v[32:35], v[80:95]
    v_mfma_f32_32x32x16_bf16 v[96:111], v[144:147], v[32:35], v[96:111]
    v_mfma_f32_32x32x16_bf16 v[112:127], v[32:35], v[148:151], v[112:127]
    s_waitcnt vmcnt(0)
    s_mov_b64 exec, 1
    ds_add_u32 v182, v181 offset:8
    s_mov_b64 exec, -1
    s_add_u32 s60, s71, 3
    s_and_b32 s60, s60, 3
    s_mul_i32 s55, s60, 196608
    s_add_u32 s55, s55, s46
    s_lshl_b32 s60, s60, 12
    s_add_u32 s60, s60, s47
    s_add_u32 m0, s60, 0
    s_nop 0
    buffer_load_dwordx4 v5, s[12:15], s55 offen offset:0 lds
    s_add_u32 m0, s60, 15360
    s_nop 0
    buffer_load_dwordx4 v5, s[12:15], s55 offen offset:1024 lds
    s_add_u32 m0, s60, 30720
    s_nop 0
    buffer_load_dwordx4 v5, s[12:15], s55 offen offset:2048 lds
    s_cmp_lg_u32 s52, 0
    s_cbranch_scc1 L_interleave_layers__softmax_full_mha__moe_arch_mod__prompt_cs_13
    v_dot2c_f32_bf16 v166, s34, v140
    v_dot2c_f32_bf16 v167, s34, v144
    v_dot2c_f32_bf16 v168, s34, v148
    v_dot2c_f32_bf16 v166, s34, v141
    v_dot2c_f32_bf16 v167, s34, v145
    v_dot2c_f32_bf16 v168, s34, v149
    v_dot2c_f32_bf16 v166, s34, v142
    v_dot2c_f32_bf16 v167, s34, v146
    v_dot2c_f32_bf16 v168, s34, v150
    v_dot2c_f32_bf16 v166, s34, v143
    v_dot2c_f32_bf16 v167, s34, v147
    v_dot2c_f32_bf16 v168, s34, v151
L_interleave_layers__softmax_full_mha__moe_arch_mod__prompt_cs_13:
    ds_read_b32 v185, v182 offset:8
    ds_read_b64_tr_b16 v[140:141], v10 offset:3072
    ds_read_b64_tr_b16 v[142:143], v11 offset:3072
    ds_read_b64_tr_b16 v[144:145], v10 offset:19456
    ds_read_b64_tr_b16 v[146:147], v11 offset:19456
    ds_read_b64_tr_b16 v[148:149], v10 offset:35840
    ds_read_b64_tr_b16 v[150:151], v11 offset:35840
    s_waitcnt lgkmcnt(12)
    v_mfma_f32_32x32x16_bf16 v[80:95], v[152:155], v[36:39], v[80:95]
    v_mfma_f32_32x32x16_bf16 v[96:111], v[156:159], v[36:39], v[96:111]
    v_mfma_f32_32x32x16_bf16 v[112:127], v[36:39], v[160:163], v[112:127]
    s_cmp_lg_u32 s52, 1
    s_cbranch_scc1 L_interleave_layers__softmax_full_mha__moe_arch_mod__prompt_cs_14
    v_dot2c_f32_bf16 v166, s34, v152
    v_dot2c_f32_bf16 v167, s34, v156
    v_dot2c_f32_bf16 v168, s34, v160
    v_dot2c_f32_bf16 v166, s34, v153
    v_dot2c_f32_bf16 v167, s34, v157
    v_dot2c_f32_bf16 v168, s34, v161
    v_dot2c_f32_bf16 v166, s34, v154
    v_dot2c_f32_bf16 v167, s34, v158
    v_dot2c_f32_bf16 v168, s34, v162
    v_dot2c_f32_bf16 v166, s34, v155
    v_dot2c_f32_bf16 v167, s34, v159
    v_dot2c_f32_bf16 v168, s34, v163
L_interleave_layers__softmax_full_mha__moe_arch_mod__prompt_cs_14:
    s_waitcnt lgkmcnt(6)
    v_readfirstlane_b32 s60, v185
    s_nop 0
    s_cmp_ge_u32 s60, 4
    s_cbranch_scc1 L_interleave_layers__softmax_full_mha__moe_arch_mod__prompt_rdy_15
    s_mov_b32 s63, 200000
L_interleave_layers__softmax_full_mha__moe_arch_mod__prompt_sp_16:
    ds_read_b32 v183, v182 offset:8
    s_waitcnt lgkmcnt(0)
    v_readfirstlane_b32 s60, v183
    s_nop 0
    s_cmp_ge_u32 s60, 4
    s_cbranch_scc1 L_interleave_layers__softmax_full_mha__moe_arch_mod__prompt_spd_17
    s_sleep 1
    s_sub_u32 s63, s63, 1
    s_cmp_lg_u32 s63, 0
    s_cbranch_scc1 L_interleave_layers__softmax_full_mha__moe_arch_mod__prompt_sp_16
L_interleave_layers__softmax_full_mha__moe_arch_mod__prompt_spd_17:
L_interleave_layers__softmax_full_mha__moe_arch_mod__prompt_rdy_15:
    ds_read_b64_tr_b16 v[152:153], v12 offset:0
    ds_read_b64_tr_b16 v[154:155], v13 offset:0
    ds_read_b64_tr_b16 v[156:157], v12 offset:16384
    ds_read_b64_tr_b16 v[158:159], v13 offset:16384
    ds_read_b64_tr_b16 v[160:161], v12 offset:32768
    ds_read_b64_tr_b16 v[162:163], v13 offset:32768
    s_waitcnt lgkmcnt(12)
    v_mfma_f32_32x32x16_bf16 v[80:95], v[128:131], v[40:43], v[80:95]
    v_mfma_f32_32x32x16_bf16 v[96:111], v[132:135], v[40:43], v[96:111]
    v_mfma_f32_32x32x16_bf16 v[112:127], v[40:43], v[136:139], v[112:127]
    s_cmp_lg_u32 s52, 2
    s_cbranch_scc1 L_interleave_layers__softmax_full_mha__moe_arch_mod__prompt_cs_18
    v_dot2c_f32_bf16 v166, s34, v128
    v_dot2c_f32_bf16 v167, s34, v132
    v_dot2c_f32_bf16 v168, s34, v136
    v_dot2c_f32_bf16 v166, s34, v129
    v_dot2c_f32_bf16 v167, s34, v133
    v_dot2c_f32_bf16 v168, s34, v137
    v_dot2c_f32_bf16 v166, s34, v130
    v_dot2c_f32_bf16 v167, s34, v134
    v_dot2c_f32_bf16 v168, s34, v138
    v_dot2c_f32_bf16 v166, s34, v131
    v_dot2c_f32_bf16 v167, s34, v135
    v_dot2c_f32_bf16 v168, s34, v139
L_interleave_layers__softmax_full_mha__moe_arch_mod__prompt_cs_18:
    ds_read_b64_tr_b16 v[128:129], v12 offset:1024
    ds_read_b64_tr_b16 v[130:131], v13 offset:1024
    ds_read_b64_tr_b16 v[132:133], v12 offset:17408
    ds_read_b64_tr_b16 v[134:135], v13 offset:17408
    ds_read_b64_tr_b16 v[136:137], v12 offset:33792
    ds_read_b64_tr_b16 v[138:139], v13 offset:33792
    s_waitcnt lgkmcnt(12)
    v_mfma_f32_32x32x16_bf16 v[80:95], v[140:143], v[44:47], v[80:95]
    v_mfma_f32_32x32x16_bf16 v[96:111], v[144:147], v[44:47], v[96:111]
    v_mfma_f32_32x32x16_bf16 v[112:127], v[44:47], v[148:151], v[112:127]
    s_cmp_lg_u32 s52, 3
    s_cbranch_scc1 L_interleave_layers__softmax_full_mha__moe_arch_mod__prompt_cs_19
    v_dot2c_f32_bf16 v166, s34, v140
    v_dot2c_f32_bf16 v167, s34, v144
    v_dot2c_f32_bf16 v168, s34, v148
    v_dot2c_f32_bf16 v166, s34, v141
    v_dot2c_f32_bf16 v167, s34, v145
    v_dot2c_f32_bf16 v168, s34, v149
    v_dot2c_f32_bf16 v166, s34, v142
    v_dot2c_f32_bf16 v167, s34, v146
    v_dot2c_f32_bf16 v168, s34, v150
    v_dot2c_f32_bf16 v166, s34, v143
    v_dot2c_f32_bf16 v167, s34, v147
    v_dot2c_f32_bf16 v168, s34, v151
L_interleave_layers__softmax_full_mha__moe_arch_mod__prompt_cs_19:
    ds_read_b64_tr_b16 v[140:141], v12 offset:2048
    ds_read_b64_tr_b16 v[142:143], v13 offset:2048
    ds_read_b64_tr_b16 v[144:145], v12 offset:18432
    ds_read_b64_tr_b16 v[146:147], v13 offset:18432
    ds_read_b64_tr_b16 v[148:149], v12 offset:34816
    ds_read_b64_tr_b16 v[150:151], v13 offset:34816
    s_waitcnt lgkmcnt(12)
    v_mfma_f32_32x32x16_bf16 v[80:95], v[152:155], v[48:51], v[80:95]
    v_mfma_f32_32x32x16_bf16 v[96:111], v[156:159], v[48:51], v[96:111]
    v_mfma_f32_32x32x16_bf16 v[112:127], v[48:51], v[160:163], v[112:127]
    s_waitcnt vmcnt(0)
    s_mov_b64 exec, 1
    ds_add_u32 v182, v181 offset:12
    s_mov_b64 exec, -1
    s_lshl_b32 s52, s5, 1
    s_lshr_b32 s53, s4, 3
    s_add_u32 s52, s52, s53
    s_lshl_b32 s52, s52, 1
    s_and_b32 s53, s6, 1
    s_add_u32 s52, s52, s53
    s_and_b32 s53, s4, 7
    s_lshl_b32 s53, s53, 2
    s_lshr_b32 s61, s6, 1
    s_add_u32 s53, s53, s61
    v_lshrrev_b32 v2, 5, v1
    v_lshlrev_b32 v7, 3, v2
    v_and_b32 v3, 31, v1
    v_lshl_add_u32 v2, v3, 10, v7
    s_lshl_b32 s54, s53, 5
    s_lshl_b32 s55, s52, 15
    s_add_u32 s55, s55, s54
    buffer_load_dwordx4 v[232:235], v4, s[56:59], 0 offen
    buffer_load_dwordx2 v[220:221], v2, s[8:11], s55 offen
    buffer_load_dwordx2 v[222:223], v2, s[8:11], s55 offen offset:16
    s_and_b32 s52, s6, 3
    s_lshr_b32 s53, s6, 2
    global_load_dword v239, v238, s[88:89] sc1
    s_lshl_b32 s54, s5, 11
    s_lshl_b32 s55, s4, 7
    s_add_u32 s54, s54, s55
    s_add_u32 s54, s54, 20971520
    v_lshlrev_b32 v2, 15, v1
    s_cmp_eq_u32 s6, 7
    s_cselect_b32 exec_lo, 0x1f, 1
    s_mov_b32 exec_hi, 0
    buffer_load_dword v236, v2, s[16:19], s54 offen sc1
    s_mov_b64 exec, -1
    s_mul_i32 s54, s2, 2944
    s_add_u32 s54, s54, 1048576
    v_lshlrev_b32 v2, 7, v1
    s_cmp_eq_u32 s6, 6
    s_cselect_b32 exec_lo, 0x7fffff, 1
    s_mov_b32 exec_hi, 0
    buffer_load_dword v237, v2, s[16:19], s54 offen sc1
    s_mov_b64 exec, -1
    s_cmp_lg_u32 s52, 0
    s_cbranch_scc1 L_interleave_layers__softmax_full_mha__moe_arch_mod__prompt_cs_20
    v_dot2c_f32_bf16 v166, s34, v152
    v_dot2c_f32_bf16 v167, s34, v156
    v_dot2c_f32_bf16 v168, s34, v160
    v_dot2c_f32_bf16 v166, s34, v153
    v_dot2c_f32_bf16 v167, s34, v157
    v_dot2c_f32_bf16 v168, s34, v161
    v_dot2c_f32_bf16 v166, s34, v154
    v_dot2c_f32_bf16 v167, s34, v158
    v_dot2c_f32_bf16 v168, s34, v162
    v_dot2c_f32_bf16 v166, s34, v155
    v_dot2c_f32_bf16 v167, s34, v159
    v_dot2c_f32_bf16 v168, s34, v163
L_interleave_layers__softmax_full_mha__moe_arch_mod__prompt_cs_20:
    ds_read_b32 v185, v182 offset:12
    ds_read_b64_tr_b16 v[152:153], v12 offset:3072
    ds_read_b64_tr_b16 v[154:155], v13 offset:3072
    ds_read_b64_tr_b16 v[156:157], v12 offset:19456
    ds_read_b64_tr_b16 v[158:159], v13 offset:19456
    ds_read_b64_tr_b16 v[160:161], v12 offset:35840
    ds_read_b64_tr_b16 v[162:163], v13 offset:35840
    s_waitcnt lgkmcnt(12)
    v_mfma_f32_32x32x16_bf16 v[80:95], v[128:131], v[52:55], v[80:95]
    v_mfma_f32_32x32x16_bf16 v[96:111], v[132:135], v[52:55], v[96:111]
    v_mfma_f32_32x32x16_bf16 v[112:127], v[52:55], v[136:139], v[112:127]
    s_cmp_lg_u32 s52, 1
    s_cbranch_scc1 L_interleave_layers__softmax_full_mha__moe_arch_mod__prompt_cs_21
    v_dot2c_f32_bf16 v166, s34, v128
    v_dot2c_f32_bf16 v167, s34, v132
    v_dot2c_f32_bf16 v168, s34, v136
    v_dot2c_f32_bf16 v166, s34, v129
    v_dot2c_f32_bf16 v167, s34, v133
    v_dot2c_f32_bf16 v168, s34, v137
    v_dot2c_f32_bf16 v166, s34, v130
    v_dot2c_f32_bf16 v167, s34, v134
    v_dot2c_f32_bf16 v168, s34, v138
    v_dot2c_f32_bf16 v166, s34, v131
    v_dot2c_f32_bf16 v167, s34, v135
    v_dot2c_f32_bf16 v168, s34, v139
L_interleave_layers__softmax_full_mha__moe_arch_mod__prompt_cs_21:
    s_waitcnt lgkmcnt(6)
    v_readfirstlane_b32 s60, v185
    s_nop 0
    s_cmp_ge_u32 s60, 4
    s_cbranch_scc1 L_interleave_layers__softmax_full_mha__moe_arch_mod__prompt_rdy_22
    s_mov_b32 s63, 200000
L_interleave_layers__softmax_full_mha__moe_arch_mod__prompt_sp_23:
    ds_read_b32 v183, v182 offset:12
    s_waitcnt lgkmcnt(0)
    v_readfirstlane_b32 s60, v183
    s_nop 0
    s_cmp_ge_u32 s60, 4
    s_cbranch_scc1 L_interleave_layers__softmax_full_mha__moe_arch_mod__prompt_spd_24
    s_sleep 1
    s_sub_u32 s63, s63, 1
    s_cmp_lg_u32 s63, 0
    s_cbranch_scc1 L_interleave_layers__softmax_full_mha__moe_arch_mod__prompt_sp_23
L_interleave_layers__softmax_full_mha__moe_arch_mod__prompt_spd_24:
L_interleave_layers__softmax_full_mha__moe_arch_mod__prompt_rdy_22:
    ds_read_b64_tr_b16 v[128:129], v14 offset:0
    ds_read_b64_tr_b16 v[130:131], v15 offset:0
    ds_read_b64_tr_b16 v[132:133], v14 offset:16384
    ds_read_b64_tr_b16 v[134:135], v15 offset:16384
    ds_read_b64_tr_b16 v[136:137], v14 offset:32768
    ds_read_b64_tr_b16 v[138:139], v15 offset:32768
    s_waitcnt lgkmcnt(12)
    v_mfma_f32_32x32x16_bf16 v[80:95], v[140:143], v[56:59], v[80:95]
    v_mfma_f32_32x32x16_bf16 v[96:111], v[144:147], v[56:59], v[96:111]
    v_mfma_f32_32x32x16_bf16 v[112:127], v[56:59], v[148:151], v[112:127]
    s_cmp_lg_u32 s52, 2
    s_cbranch_scc1 L_interleave_layers__softmax_full_mha__moe_arch_mod__prompt_cs_25
    v_dot2c_f32_bf16 v166, s34, v140
    v_dot2c_f32_bf16 v167, s34, v144
    v_dot2c_f32_bf16 v168, s34, v148
    v_dot2c_f32_bf16 v166, s34, v141
    v_dot2c_f32_bf16 v167, s34, v145
    v_dot2c_f32_bf16 v168, s34, v149
    v_dot2c_f32_bf16 v166, s34, v142
    v_dot2c_f32_bf16 v167, s34, v146
    v_dot2c_f32_bf16 v168, s34, v150
    v_dot2c_f32_bf16 v166, s34, v143
    v_dot2c_f32_bf16 v167, s34, v147
    v_dot2c_f32_bf16 v168, s34, v151
L_interleave_layers__softmax_full_mha__moe_arch_mod__prompt_cs_25:
    ds_read_b64_tr_b16 v[140:141], v14 offset:1024
    ds_read_b64_tr_b16 v[142:143], v15 offset:1024
    ds_read_b64_tr_b16 v[144:145], v14 offset:17408
    ds_read_b64_tr_b16 v[146:147], v15 offset:17408
    ds_read_b64_tr_b16 v[148:149], v14 offset:33792
    ds_read_b64_tr_b16 v[150:151], v15 offset:33792
    s_waitcnt lgkmcnt(12)
    v_mfma_f32_32x32x16_bf16 v[80:95], v[152:155], v[60:63], v[80:95]
    v_mfma_f32_32x32x16_bf16 v[96:111], v[156:159], v[60:63], v[96:111]
    v_mfma_f32_32x32x16_bf16 v[112:127], v[60:63], v[160:163], v[112:127]
    s_cmp_lg_u32 s52, 3
    s_cbranch_scc1 L_interleave_layers__softmax_full_mha__moe_arch_mod__prompt_cs_26
    v_dot2c_f32_bf16 v166, s34, v152
    v_dot2c_f32_bf16 v167, s34, v156
    v_dot2c_f32_bf16 v168, s34, v160
    v_dot2c_f32_bf16 v166, s34, v153
    v_dot2c_f32_bf16 v167, s34, v157
    v_dot2c_f32_bf16 v168, s34, v161
    v_dot2c_f32_bf16 v166, s34, v154
    v_dot2c_f32_bf16 v167, s34, v158
    v_dot2c_f32_bf16 v168, s34, v162
    v_dot2c_f32_bf16 v166, s34, v155
    v_dot2c_f32_bf16 v167, s34, v159
    v_dot2c_f32_bf16 v168, s34, v163
L_interleave_layers__softmax_full_mha__moe_arch_mod__prompt_cs_26:
    ds_read_b64_tr_b16 v[152:153], v14 offset:2048
    ds_read_b64_tr_b16 v[154:155], v15 offset:2048
    ds_read_b64_tr_b16 v[156:157], v14 offset:18432
    ds_read_b64_tr_b16 v[158:159], v15 offset:18432
    ds_read_b64_tr_b16 v[160:161], v14 offset:34816
    ds_read_b64_tr_b16 v[162:163], v15 offset:34816
    s_waitcnt lgkmcnt(12)
    v_mfma_f32_32x32x16_bf16 v[80:95], v[128:131], v[64:67], v[80:95]
    v_mfma_f32_32x32x16_bf16 v[96:111], v[132:135], v[64:67], v[96:111]
    v_mfma_f32_32x32x16_bf16 v[112:127], v[64:67], v[136:139], v[112:127]
    s_cmp_lg_u32 s52, 0
    s_cbranch_scc1 L_interleave_layers__softmax_full_mha__moe_arch_mod__prompt_cs_27
    v_dot2c_f32_bf16 v166, s34, v128
    v_dot2c_f32_bf16 v167, s34, v132
    v_dot2c_f32_bf16 v168, s34, v136
    v_dot2c_f32_bf16 v166, s34, v129
    v_dot2c_f32_bf16 v167, s34, v133
    v_dot2c_f32_bf16 v168, s34, v137
    v_dot2c_f32_bf16 v166, s34, v130
    v_dot2c_f32_bf16 v167, s34, v134
    v_dot2c_f32_bf16 v168, s34, v138
    v_dot2c_f32_bf16 v166, s34, v131
    v_dot2c_f32_bf16 v167, s34, v135
    v_dot2c_f32_bf16 v168, s34, v139
L_interleave_layers__softmax_full_mha__moe_arch_mod__prompt_cs_27:
    ds_read_b64_tr_b16 v[128:129], v14 offset:3072
    ds_read_b64_tr_b16 v[130:131], v15 offset:3072
    ds_read_b64_tr_b16 v[132:133], v14 offset:19456
    ds_read_b64_tr_b16 v[134:135], v15 offset:19456
    ds_read_b64_tr_b16 v[136:137], v14 offset:35840
    ds_read_b64_tr_b16 v[138:139], v15 offset:35840
    s_waitcnt lgkmcnt(12)
    v_mfma_f32_32x32x16_bf16 v[80:95], v[140:143], v[68:71], v[80:95]
    v_mfma_f32_32x32x16_bf16 v[96:111], v[144:147], v[68:71], v[96:111]
    v_mfma_f32_32x32x16_bf16 v[112:127], v[68:71], v[148:151], v[112:127]
    s_cmp_lg_u32 s52, 1
    s_cbranch_scc1 L_interleave_layers__softmax_full_mha__moe_arch_mod__prompt_cs_28
    v_dot2c_f32_bf16 v166, s34, v140
    v_dot2c_f32_bf16 v167, s34, v144
    v_dot2c_f32_bf16 v168, s34, v148
    v_dot2c_f32_bf16 v166, s34, v141
    v_dot2c_f32_bf16 v167, s34, v145
    v_dot2c_f32_bf16 v168, s34, v149
    v_dot2c_f32_bf16 v166, s34, v142
    v_dot2c_f32_bf16 v167, s34, v146
    v_dot2c_f32_bf16 v168, s34, v150
    v_dot2c_f32_bf16 v166, s34, v143
    v_dot2c_f32_bf16 v167, s34, v147
    v_dot2c_f32_bf16 v168, s34, v151
L_interleave_layers__softmax_full_mha__moe_arch_mod__prompt_cs_28:
    s_waitcnt lgkmcnt(6)
    v_mfma_f32_32x32x16_bf16 v[80:95], v[152:155], v[72:75], v[80:95]
    v_mfma_f32_32x32x16_bf16 v[96:111], v[156:159], v[72:75], v[96:111]
    v_mfma_f32_32x32x16_bf16 v[112:127], v[72:75], v[160:163], v[112:127]
    s_cmp_lg_u32 s52, 2
    s_cbranch_scc1 L_interleave_layers__softmax_full_mha__moe_arch_mod__prompt_cs_29
    v_dot2c_f32_bf16 v166, s34, v152
    v_dot2c_f32_bf16 v167, s34, v156
    v_dot2c_f32_bf16 v168, s34, v160
    v_dot2c_f32_bf16 v166, s34, v153
    v_dot2c_f32_bf16 v167, s34, v157
    v_dot2c_f32_bf16 v168, s34, v161
    v_dot2c_f32_bf16 v166, s34, v154
    v_dot2c_f32_bf16 v167, s34, v158
    v_dot2c_f32_bf16 v168, s34, v162
    v_dot2c_f32_bf16 v166, s34, v155
    v_dot2c_f32_bf16 v167, s34, v159
    v_dot2c_f32_bf16 v168, s34, v163
L_interleave_layers__softmax_full_mha__moe_arch_mod__prompt_cs_29:
    s_waitcnt lgkmcnt(0)
    v_mfma_f32_32x32x16_bf16 v[80:95], v[128:131], v[76:79], v[80:95]
    v_mfma_f32_32x32x16_bf16 v[96:111], v[132:135], v[76:79], v[96:111]
    v_mfma_f32_32x32x16_bf16 v[112:127], v[76:79], v[136:139], v[112:127]
    s_cmp_lg_u32 s52, 3
    s_cbranch_scc1 L_interleave_layers__softmax_full_mha__moe_arch_mod__prompt_cs_30
    v_dot2c_f32_bf16 v166, s34, v128
    v_dot2c_f32_bf16 v167, s34, v132
    v_dot2c_f32_bf16 v168, s34, v136
    v_dot2c_f32_bf16 v166, s34, v129
    v_dot2c_f32_bf16 v167, s34, v133
    v_dot2c_f32_bf16 v168, s34, v137
    v_dot2c_f32_bf16 v166, s34, v130
    v_dot2c_f32_bf16 v167, s34, v134
    v_dot2c_f32_bf16 v168, s34, v138
    v_dot2c_f32_bf16 v166, s34, v131
    v_dot2c_f32_bf16 v167, s34, v135
    v_dot2c_f32_bf16 v168, s34, v139
L_interleave_layers__softmax_full_mha__moe_arch_mod__prompt_cs_30:
    s_nop 0
    v_mov_b32 v12, v166
    v_mov_b32 v13, v167
    v_mov_b32 v14, v168
    v_permlane32_swap_b32 v166, v12
    v_permlane32_swap_b32 v167, v13
    v_permlane32_swap_b32 v168, v14
    v_add_f32 v166, v166, v12
    v_add_f32 v167, v167, v13
    v_add_f32 v168, v168, v14
    s_lshl_b32 s56, s6, 2
    s_add_u32 s56, s56, 147456
    v_and_b32 v2, 31, v1
    v_lshl_add_u32 v2, v2, 5, s56
    ds_write_b32 v2, v166
    ds_write_b32 v2, v167 offset:1024
    ds_write_b32 v2, v168 offset:2048
    s_mov_b64 exec, 1
    ds_add_u32 v180, v181 offset:48
    s_mov_b64 exec, -1
    s_mov_b32 s63, 200000
    s_waitcnt vmcnt(0)
L_interleave_layers__softmax_full_mha__moe_arch_mod__prompt_tag_31:
    v_readfirstlane_b32 s3, v239
    s_nop 0
    s_cmp_lg_u32 s3, 0
    s_cbranch_scc1 L_interleave_layers__softmax_full_mha__moe_arch_mod__prompt_tagd_32
    global_load_dword v239, v238, s[88:89] sc1
    s_sub_u32 s63, s63, 1
    s_waitcnt vmcnt(0)
    s_cmp_lg_u32 s63, 0
    s_cbranch_scc1 L_interleave_layers__softmax_full_mha__moe_arch_mod__prompt_tag_31
L_interleave_layers__softmax_full_mha__moe_arch_mod__prompt_tagd_32:
    s_branch L_Gx
L_G:
    ds_read_b64_tr_b16 v[128:129], v8 offset:0
    ds_read_b64_tr_b16 v[130:131], v9 offset:0
    ds_read_b64_tr_b16 v[132:133], v8 offset:16384
    ds_read_b64_tr_b16 v[134:135], v9 offset:16384
    ds_read_b64_tr_b16 v[136:137], v8 offset:32768
    ds_read_b64_tr_b16 v[138:139], v9 offset:32768
    ds_read_b64_tr_b16 v[140:141], v8 offset:1024
    ds_read_b64_tr_b16 v[142:143], v9 offset:1024
    ds_read_b64_tr_b16 v[144:145], v8 offset:17408
    ds_read_b64_tr_b16 v[146:147], v9 offset:17408
    ds_read_b64_tr_b16 v[148:149], v8 offset:33792
    ds_read_b64_tr_b16 v[150:151], v9 offset:33792
    ds_read_b64_tr_b16 v[152:153], v8 offset:2048
    ds_read_b64_tr_b16 v[154:155], v9 offset:2048
    ds_read_b64_tr_b16 v[156:157], v8 offset:18432
    ds_read_b64_tr_b16 v[158:159], v9 offset:18432
    ds_read_b64_tr_b16 v[160:161], v8 offset:34816
    ds_read_b64_tr_b16 v[162:163], v9 offset:34816
    s_waitcnt lgkmcnt(12) vmcnt(4)
    v_mfma_f32_32x32x16_bf16 v[80:95], v[128:131], v[16:19], 0
    v_mfma_f32_32x32x16_bf16 v[96:111], v[132:135], v[16:19], 0
    v_mfma_f32_32x32x16_bf16 v[112:127], v[16:19], v[136:139], 0
    s_add_u32 s56, s71, 2
    s_and_b32 s56, s56, 3
    s_lshl_b32 s56, s56, 12
    s_add_u32 s56, s56, s70
    buffer_load_dwordx4 v[48:51], v4, s[16:19], s56 offen offset:0 sc1
    buffer_load_dwordx4 v[52:55], v4, s[16:19], s56 offen offset:1024 sc1
    buffer_load_dwordx4 v[56:59], v4, s[16:19], s56 offen offset:2048 sc1
    buffer_load_dwordx4 v[60:63], v4, s[16:19], s56 offen offset:3072 sc1
    ds_read_b64_tr_b16 v[128:129], v8 offset:3072
    ds_read_b64_tr_b16 v[130:131], v9 offset:3072
    ds_read_b64_tr_b16 v[132:133], v8 offset:19456
    ds_read_b64_tr_b16 v[134:135], v9 offset:19456
    ds_read_b64_tr_b16 v[136:137], v8 offset:35840
    ds_read_b64_tr_b16 v[138:139], v9 offset:35840
    s_waitcnt lgkmcnt(12)
    v_mfma_f32_32x32x16_bf16 v[80:95], v[140:143], v[20:23], v[80:95]
    v_mfma_f32_32x32x16_bf16 v[96:111], v[144:147], v[20:23], v[96:111]
    v_mfma_f32_32x32x16_bf16 v[112:127], v[20:23], v[148:151], v[112:127]
    s_cmp_lg_u32 s53, 0
    s_cbranch_scc1 L_interleave_layers__softmax_full_mha__moe_arch_mod__prompt_rp_33
    s_mov_b32 s63, 200000
    s_branch L_interleave_layers__softmax_full_mha__moe_arch_mod__prompt_pollc_36
L_interleave_layers__softmax_full_mha__moe_arch_mod__prompt_poll_34:
    buffer_load_dwordx4 v[176:179], v5, s[16:19], s86 offen offset:0 sc1
    buffer_load_dwordx4 v[180:183], v5, s[16:19], s86 offen offset:1024 sc1
    buffer_load_dwordx4 v[184:187], v5, s[16:19], s86 offen offset:2048 sc1
    buffer_load_dwordx4 v[188:191], v5, s[16:19], s86 offen offset:3072 sc1
    s_waitcnt vmcnt(0)
L_interleave_layers__softmax_full_mha__moe_arch_mod__prompt_pollc_36:
    v_cmp_ne_u32 vcc, s3, v179
    v_cmp_ne_u32 s[60:61], s3, v183
    s_nop 0
    s_or_b64 vcc, vcc, s[60:61]
    v_cmp_ne_u32 s[60:61], s3, v187
    s_nop 0
    s_or_b64 vcc, vcc, s[60:61]
    v_cmp_ne_u32 s[60:61], s3, v191
    s_nop 0
    s_or_b64 vcc, vcc, s[60:61]
    s_cbranch_vccz L_interleave_layers__softmax_full_mha__moe_arch_mod__prompt_polld_35
    s_sleep 1
    s_sub_u32 s63, s63, 1
    s_cmp_lg_u32 s63, 0
    s_cbranch_scc1 L_interleave_layers__softmax_full_mha__moe_arch_mod__prompt_poll_34
L_interleave_layers__softmax_full_mha__moe_arch_mod__prompt_polld_35:
    v_add_f32 v176, v176, v180
    v_add_f32 v184, v184, v188
    v_add_f32 v177, v177, v181
    v_add_f32 v185, v185, v189
    v_add_f32 v178, v178, v182
    v_add_f32 v186, v186, v190
    v_add_f32 v164, v176, v184
    v_add_f32 v165, v177, v185
    v_add_f32 v166, v178, v186
    v_mov_b32 v180, v164
    v_mov_b32 v181, v165
    v_mov_b32 v182, v166
    v_permlane32_swap_b32 v164, v180
    v_permlane32_swap_b32 v165, v181
    v_permlane32_swap_b32 v166, v182
    v_add_f32 v164, v164, v180
    v_add_f32 v165, v165, v181
    v_add_f32 v166, v166, v182
L_interleave_layers__softmax_full_mha__moe_arch_mod__prompt_rp_33:
    ds_read_b64_tr_b16 v[140:141], v10 offset:0
    ds_read_b64_tr_b16 v[142:143], v11 offset:0
    ds_read_b64_tr_b16 v[144:145], v10 offset:16384
    ds_read_b64_tr_b16 v[146:147], v11 offset:16384
    ds_read_b64_tr_b16 v[148:149], v10 offset:32768
    ds_read_b64_tr_b16 v[150:151], v11 offset:32768
    s_waitcnt lgkmcnt(12)
    v_mfma_f32_32x32x16_bf16 v[80:95], v[152:155], v[24:27], v[80:95]
    v_mfma_f32_32x32x16_bf16 v[96:111], v[156:159], v[24:27], v[96:111]
    v_mfma_f32_32x32x16_bf16 v[112:127], v[24:27], v[160:163], v[112:127]
    s_cmp_lg_u32 s53, 0
    s_cbranch_scc1 L_interleave_layers__softmax_full_mha__moe_arch_mod__prompt_rp_37
    v_mul_f32 v164, 0x3b000000, v164
    v_mul_f32 v165, 0x3b000000, v165
    v_fma_f32 v165, -v164, v164, v165
    v_max_f32 v165, 0, v165
    v_cvt_pk_bf16_f32 v167, v164, v165
    v_and_b32 v176, 0xffff0000, v167
    v_lshlrev_b32 v167, 16, v167
    v_add_f32 v176, 925353388, v176
    v_cvt_pk_bf16_f32 v176, v176, v176
    v_and_b32 v176, 0xffff0000, v176
    v_sqrt_f32 v176, v176
    s_nop 0
    v_cvt_pk_bf16_f32 v176, v176, v176
    v_and_b32 v176, 0xffff0000, v176
    v_rcp_f32 v168, v176
    s_and_b32 s54, s43, 3
    s_lshl_b32 s56, s54, 7
    s_add_u32 s56, s56, 152576
    v_and_b32 v177, 31, v1
    v_lshl_add_u32 v169, v177, 2, s56
    v_mov_b32 v176, s28
    v_fma_f32 v166, -v167, v176, v166
    v_mul_f32 v166, v166, v168
    v_cvt_pk_bf16_f32 v166, v166, v166
    ds_write2st64_b32 v169, v167, v168 offset0:4 offset1:6
    v_ashrrev_i32 v176, 31, v166
    v_or_b32 v176, 0x80000000, v176
    v_xor_b32 v166, v166, v176
    v_and_b32 v166, 0xffff0000, v166
    s_lshl_b32 s56, s43, 5
    s_sub_u32 s56, 2047, s56
    v_sub_u32 v176, s56, v177
    v_or_b32 v166, v166, v176
    ds_write_b32 v169, v166 offset:2048
L_interleave_layers__softmax_full_mha__moe_arch_mod__prompt_rp_37:
    ds_read_b64_tr_b16 v[152:153], v10 offset:1024
    ds_read_b64_tr_b16 v[154:155], v11 offset:1024
    ds_read_b64_tr_b16 v[156:157], v10 offset:17408
    ds_read_b64_tr_b16 v[158:159], v11 offset:17408
    ds_read_b64_tr_b16 v[160:161], v10 offset:33792
    ds_read_b64_tr_b16 v[162:163], v11 offset:33792
    s_waitcnt lgkmcnt(12)
    v_mfma_f32_32x32x16_bf16 v[80:95], v[128:131], v[28:31], v[80:95]
    v_mfma_f32_32x32x16_bf16 v[96:111], v[132:135], v[28:31], v[96:111]
    v_mfma_f32_32x32x16_bf16 v[112:127], v[28:31], v[136:139], v[112:127]
    s_cmp_lg_u32 s53, 0
    s_cbranch_scc1 L_interleave_layers__softmax_full_mha__moe_arch_mod__prompt_rp_38
    v_max_u32_dpp v166, v166, v166 row_shr:1 row_mask:0xf bank_mask:0xf
    s_nop 1
    v_max_u32_dpp v166, v166, v166 row_shr:2 row_mask:0xf bank_mask:0xf
    s_nop 1
    v_max_u32_dpp v166, v166, v166 row_shr:4 row_mask:0xf bank_mask:0xf
    s_nop 1
    v_max_u32_dpp v166, v166, v166 row_shr:8 row_mask:0xf bank_mask:0xf
    s_nop 1
    v_max_u32_dpp v166, v166, v166 row_bcast:15 row_mask:0xa bank_mask:0xf
    s_nop 1
    v_max_u32_dpp v166, v166, v166 row_bcast:31 row_mask:0xc bank_mask:0xf
    s_and_b32 s54, s43, 3
    s_lshl_b32 s54, s54, 2
    s_add_u32 s54, s54, 155136
    v_mov_b32 v3, s54
    v_mov_b32 v176, v166
    v_mov_b32 v177, s3
    v_mov_b32 v178, 0
    s_lshl_b32 s54, s43, 10
    s_and_b32 s56, s4, 7
    s_lshl_b32 s56, s56, 7
    s_add_u32 s54, s54, s56
    s_lshl_b32 s56, s7, 16
    s_add_u32 s54, s54, s56
    s_add_u32 s54, s54, 1507328
    s_mov_b32 exec_lo, 0
    s_mov_b32 exec_hi, 0x80000000
    buffer_store_dwordx2 v[176:177], v178, s[16:19], s54 offen sc1
    ds_write_b32 v3, v166
    s_mov_b64 exec, -1
L_interleave_layers__softmax_full_mha__moe_arch_mod__prompt_rp_38:
    ds_read_b64_tr_b16 v[128:129], v10 offset:2048
    ds_read_b64_tr_b16 v[130:131], v11 offset:2048
    ds_read_b64_tr_b16 v[132:133], v10 offset:18432
    ds_read_b64_tr_b16 v[134:135], v11 offset:18432
    ds_read_b64_tr_b16 v[136:137], v10 offset:34816
    ds_read_b64_tr_b16 v[138:139], v11 offset:34816
    s_waitcnt lgkmcnt(12) vmcnt(4)
    v_mfma_f32_32x32x16_bf16 v[80:95], v[140:143], v[32:35], v[80:95]
    v_mfma_f32_32x32x16_bf16 v[96:111], v[144:147], v[32:35], v[96:111]
    v_mfma_f32_32x32x16_bf16 v[112:127], v[32:35], v[148:151], v[112:127]
    s_add_u32 s56, s71, 3
    s_and_b32 s56, s56, 3
    s_lshl_b32 s56, s56, 12
    s_add_u32 s56, s56, s70
    buffer_load_dwordx4 v[64:67], v4, s[16:19], s56 offen offset:0 sc1
    buffer_load_dwordx4 v[68:71], v4, s[16:19], s56 offen offset:1024 sc1
    buffer_load_dwordx4 v[72:75], v4, s[16:19], s56 offen offset:2048 sc1
    buffer_load_dwordx4 v[76:79], v4, s[16:19], s56 offen offset:3072 sc1
    s_cmp_lg_u32 s53, 0
    s_cbranch_scc1 L_interleave_layers__softmax_full_mha__moe_arch_mod__prompt_rp_39
    v_add_f32 v180, 1.0, v168
    v_sub_f32 v181, v164, v167
    v_fma_f32 v164, v181, v168, v164
    v_mul_f32 v165, v165, v180
    v_mul_f32 v165, v165, v180
    v_cvt_pk_bf16_f32 v181, v164, v165
    v_and_b32 v182, 0xffff0000, v181
    v_lshlrev_b32 v181, 16, v181
    v_add_f32 v182, 925353388, v182
    v_cvt_pk_bf16_f32 v182, v182, v182
    v_and_b32 v182, 0xffff0000, v182
    v_sqrt_f32 v182, v182
    s_nop 0
    v_cvt_pk_bf16_f32 v182, v182, v182
    v_and_b32 v182, 0xffff0000, v182
    v_rcp_f32 v182, v182
    v_fma_f32 v167, v167, v168, v181
    v_mul_f32 v167, v167, v182
    v_mul_f32 v180, v180, v182
    ds_write2st64_b32 v169, v180, v167 offset0:0 offset1:2
L_interleave_layers__softmax_full_mha__moe_arch_mod__prompt_rp_39:
    ds_read_b64_tr_b16 v[140:141], v10 offset:3072
    ds_read_b64_tr_b16 v[142:143], v11 offset:3072
    ds_read_b64_tr_b16 v[144:145], v10 offset:19456
    ds_read_b64_tr_b16 v[146:147], v11 offset:19456
    ds_read_b64_tr_b16 v[148:149], v10 offset:35840
    ds_read_b64_tr_b16 v[150:151], v11 offset:35840
    s_waitcnt lgkmcnt(12)
    v_mfma_f32_32x32x16_bf16 v[80:95], v[152:155], v[36:39], v[80:95]
    v_mfma_f32_32x32x16_bf16 v[96:111], v[156:159], v[36:39], v[96:111]
    v_mfma_f32_32x32x16_bf16 v[112:127], v[36:39], v[160:163], v[112:127]
    ds_read_b64_tr_b16 v[152:153], v12 offset:0
    ds_read_b64_tr_b16 v[154:155], v13 offset:0
    ds_read_b64_tr_b16 v[156:157], v12 offset:16384
    ds_read_b64_tr_b16 v[158:159], v13 offset:16384
    ds_read_b64_tr_b16 v[160:161], v12 offset:32768
    ds_read_b64_tr_b16 v[162:163], v13 offset:32768
    s_waitcnt lgkmcnt(12)
    v_mfma_f32_32x32x16_bf16 v[80:95], v[128:131], v[40:43], v[80:95]
    v_mfma_f32_32x32x16_bf16 v[96:111], v[132:135], v[40:43], v[96:111]
    v_mfma_f32_32x32x16_bf16 v[112:127], v[40:43], v[136:139], v[112:127]
    ds_read_b64_tr_b16 v[128:129], v12 offset:1024
    ds_read_b64_tr_b16 v[130:131], v13 offset:1024
    ds_read_b64_tr_b16 v[132:133], v12 offset:17408
    ds_read_b64_tr_b16 v[134:135], v13 offset:17408
    ds_read_b64_tr_b16 v[136:137], v12 offset:33792
    ds_read_b64_tr_b16 v[138:139], v13 offset:33792
    s_waitcnt lgkmcnt(12)
    v_mfma_f32_32x32x16_bf16 v[80:95], v[140:143], v[44:47], v[80:95]
    v_mfma_f32_32x32x16_bf16 v[96:111], v[144:147], v[44:47], v[96:111]
    v_mfma_f32_32x32x16_bf16 v[112:127], v[44:47], v[148:151], v[112:127]
    ds_read_b64_tr_b16 v[140:141], v12 offset:2048
    ds_read_b64_tr_b16 v[142:143], v13 offset:2048
    ds_read_b64_tr_b16 v[144:145], v12 offset:18432
    ds_read_b64_tr_b16 v[146:147], v13 offset:18432
    ds_read_b64_tr_b16 v[148:149], v12 offset:34816
    ds_read_b64_tr_b16 v[150:151], v13 offset:34816
    s_waitcnt lgkmcnt(12) vmcnt(4)
    v_mfma_f32_32x32x16_bf16 v[80:95], v[152:155], v[48:51], v[80:95]
    v_mfma_f32_32x32x16_bf16 v[96:111], v[156:159], v[48:51], v[96:111]
    v_mfma_f32_32x32x16_bf16 v[112:127], v[48:51], v[160:163], v[112:127]
    ds_read_b64_tr_b16 v[152:153], v12 offset:3072
    ds_read_b64_tr_b16 v[154:155], v13 offset:3072
    ds_read_b64_tr_b16 v[156:157], v12 offset:19456
    ds_read_b64_tr_b16 v[158:159], v13 offset:19456
    ds_read_b64_tr_b16 v[160:161], v12 offset:35840
    ds_read_b64_tr_b16 v[162:163], v13 offset:35840
    s_waitcnt lgkmcnt(12)
    v_mfma_f32_32x32x16_bf16 v[80:95], v[128:131], v[52:55], v[80:95]
    v_mfma_f32_32x32x16_bf16 v[96:111], v[132:135], v[52:55], v[96:111]
    v_mfma_f32_32x32x16_bf16 v[112:127], v[52:55], v[136:139], v[112:127]
    s_waitcnt lgkmcnt(6)
    s_barrier
    ds_read_b64_tr_b16 v[128:129], v14 offset:0
    ds_read_b64_tr_b16 v[130:131], v15 offset:0
    ds_read_b64_tr_b16 v[132:133], v14 offset:16384
    ds_read_b64_tr_b16 v[134:135], v15 offset:16384
    ds_read_b64_tr_b16 v[136:137], v14 offset:32768
    ds_read_b64_tr_b16 v[138:139], v15 offset:32768
    s_waitcnt lgkmcnt(12)
    v_mfma_f32_32x32x16_bf16 v[80:95], v[140:143], v[56:59], v[80:95]
    v_mfma_f32_32x32x16_bf16 v[96:111], v[144:147], v[56:59], v[96:111]
    v_mfma_f32_32x32x16_bf16 v[112:127], v[56:59], v[148:151], v[112:127]
    s_and_b32 s54, s40, 3
    s_lshl_b32 s56, s54, 7
    s_add_u32 s56, s56, 152576
    v_and_b32 v3, 31, v1
    v_lshl_add_u32 v2, v3, 2, s56
    ds_read2st64_b32 v[164:165], v2 offset0:4 offset1:6
    ds_read_b32 v186, v2 offset:2048
    s_lshl_b32 s54, s54, 2
    s_add_u32 s54, s54, 155136
    v_mov_b32 v3, s54
    ds_read_b32 v166, v3
    v_mov_b32 v179, s3
    v_mov_b32 v181, v220
    v_mov_b32 v182, v221
    v_mov_b32 v183, s3
    v_mov_b32 v184, v222
    v_mov_b32 v185, v223
    v_mov_b32 v187, s3
    v_lshrrev_b32 v167, 5, v1
    v_mul_u32_u24 v167, 48, v167
    ds_read_b64_tr_b16 v[140:141], v14 offset:1024
    ds_read_b64_tr_b16 v[142:143], v15 offset:1024
    ds_read_b64_tr_b16 v[144:145], v14 offset:17408
    ds_read_b64_tr_b16 v[146:147], v15 offset:17408
    ds_read_b64_tr_b16 v[148:149], v14 offset:33792
    ds_read_b64_tr_b16 v[150:151], v15 offset:33792
    s_waitcnt lgkmcnt(12)
    v_mfma_f32_32x32x16_bf16 v[80:95], v[152:155], v[60:63], v[80:95]
    v_mfma_f32_32x32x16_bf16 v[96:111], v[156:159], v[60:63], v[96:111]
    v_mfma_f32_32x32x16_bf16 v[112:127], v[60:63], v[160:163], v[112:127]
    ds_read_b64_tr_b16 v[152:153], v14 offset:2048
    ds_read_b64_tr_b16 v[154:155], v15 offset:2048
    ds_read_b64_tr_b16 v[156:157], v14 offset:18432
    ds_read_b64_tr_b16 v[158:159], v15 offset:18432
    ds_read_b64_tr_b16 v[160:161], v14 offset:34816
    ds_read_b64_tr_b16 v[162:163], v15 offset:34816
    s_waitcnt lgkmcnt(12) vmcnt(0)
    v_mfma_f32_32x32x16_bf16 v[80:95], v[128:131], v[64:67], v[80:95]
    v_mfma_f32_32x32x16_bf16 v[96:111], v[132:135], v[64:67], v[96:111]
    v_mfma_f32_32x32x16_bf16 v[112:127], v[64:67], v[136:139], v[112:127]
    v_cmp_eq_u32 vcc, v166, v186
    s_nop 0
    s_mov_b64 s[48:49], vcc
    s_mov_b64 exec, vcc
    buffer_store_dwordx4 v[184:187], v167, s[16:19], s85 offen offset:32 sc1
    s_mov_b64 exec, -1
    v_lshlrev_b32 v188, 16, v220
    v_and_b32 v189, 0xffff0000, v220
    v_sub_f32 v188, v188, v164
    v_sub_f32 v189, v189, v164
    v_cvt_pk_bf16_f32 v188, v188, v189
    v_and_b32 v189, 0xffff0000, v188
    v_lshlrev_b32 v188, 16, v188
    v_mul_f32 v188, v188, v165
    v_mul_f32 v189, v189, v165
    v_cvt_pk_bf16_f32 v172, v188, v189
    v_lshlrev_b32 v188, 16, v221
    v_and_b32 v189, 0xffff0000, v221
    v_sub_f32 v188, v188, v164
    v_sub_f32 v189, v189, v164
    v_cvt_pk_bf16_f32 v188, v188, v189
    v_and_b32 v189, 0xffff0000, v188
    v_lshlrev_b32 v188, 16, v188
    v_mul_f32 v188, v188, v165
    v_mul_f32 v189, v189, v165
    v_cvt_pk_bf16_f32 v173, v188, v189
    ds_read_b64_tr_b16 v[128:129], v14 offset:3072
    ds_read_b64_tr_b16 v[130:131], v15 offset:3072
    ds_read_b64_tr_b16 v[132:133], v14 offset:19456
    ds_read_b64_tr_b16 v[134:135], v15 offset:19456
    ds_read_b64_tr_b16 v[136:137], v14 offset:35840
    ds_read_b64_tr_b16 v[138:139], v15 offset:35840
    s_waitcnt lgkmcnt(12)
    v_mfma_f32_32x32x16_bf16 v[80:95], v[140:143], v[68:71], v[80:95]
    v_mfma_f32_32x32x16_bf16 v[96:111], v[144:147], v[68:71], v[96:111]
    v_mfma_f32_32x32x16_bf16 v[112:127], v[68:71], v[148:151], v[112:127]
    v_lshlrev_b32 v188, 16, v222
    v_and_b32 v189, 0xffff0000, v222
    v_sub_f32 v188, v188, v164
    v_sub_f32 v189, v189, v164
    v_cvt_pk_bf16_f32 v188, v188, v189
    v_and_b32 v189, 0xffff0000, v188
    v_lshlrev_b32 v188, 16, v188
    v_mul_f32 v188, v188, v165
    v_mul_f32 v189, v189, v165
    v_cvt_pk_bf16_f32 v174, v188, v189
    v_lshlrev_b32 v188, 16, v223
    v_and_b32 v189, 0xffff0000, v223
    v_sub_f32 v188, v188, v164
    v_sub_f32 v189, v189, v164
    v_cvt_pk_bf16_f32 v188, v188, v189
    v_and_b32 v189, 0xffff0000, v188
    v_lshlrev_b32 v188, 16, v188
    v_mul_f32 v188, v188, v165
    v_mul_f32 v189, v189, v165
    v_cvt_pk_bf16_f32 v175, v188, v189
    v_mov_b32 v176, v172
    v_mov_b32 v177, v173
    v_mov_b32 v178, v174
    v_mov_b32 v180, v175
    s_mov_b64 exec, s[48:49]
    buffer_store_dwordx4 v[176:179], v167, s[16:19], s85 offen sc1
    buffer_store_dwordx4 v[180:183], v167, s[16:19], s85 offen offset:16 sc1
    s_mov_b64 exec, -1
    s_waitcnt lgkmcnt(6)
    v_mfma_f32_32x32x16_bf16 v[80:95], v[152:155], v[72:75], v[80:95]
    v_mfma_f32_32x32x16_bf16 v[96:111], v[156:159], v[72:75], v[96:111]
    v_mfma_f32_32x32x16_bf16 v[112:127], v[72:75], v[160:163], v[112:127]
    v_lshlrev_b32 v188, 16, v220
    v_and_b32 v189, 0xffff0000, v220
    v_lshlrev_b32 v190, 16, v172
    v_and_b32 v191, 0xffff0000, v172
    v_add_f32 v188, v188, v190
    v_add_f32 v189, v189, v191
    v_cvt_pk_bf16_f32 v220, v188, v189
    v_lshlrev_b32 v188, 16, v221
    v_and_b32 v189, 0xffff0000, v221
    v_lshlrev_b32 v190, 16, v173
    v_and_b32 v191, 0xffff0000, v173
    v_add_f32 v188, v188, v190
    v_add_f32 v189, v189, v191
    v_cvt_pk_bf16_f32 v221, v188, v189
    v_lshlrev_b32 v188, 16, v222
    v_and_b32 v189, 0xffff0000, v222
    v_lshlrev_b32 v190, 16, v174
    v_and_b32 v191, 0xffff0000, v174
    v_add_f32 v188, v188, v190
    v_add_f32 v189, v189, v191
    v_cvt_pk_bf16_f32 v222, v188, v189
    v_lshlrev_b32 v188, 16, v223
    v_and_b32 v189, 0xffff0000, v223
    v_lshlrev_b32 v190, 16, v175
    v_and_b32 v191, 0xffff0000, v175
    v_add_f32 v188, v188, v190
    v_add_f32 v189, v189, v191
    v_cvt_pk_bf16_f32 v223, v188, v189
    s_waitcnt lgkmcnt(0)
    v_mfma_f32_32x32x16_bf16 v[80:95], v[128:131], v[76:79], v[80:95]
    v_mfma_f32_32x32x16_bf16 v[96:111], v[132:135], v[76:79], v[96:111]
    v_mfma_f32_32x32x16_bf16 v[112:127], v[76:79], v[136:139], v[112:127]
L_Gx:
    s_lshl_b32 s54, s52, 12
    s_lshl_b32 s55, s52, 13
    s_add_u32 s54, s54, 98304
    s_add_u32 s55, s55, 114688
    v_add_u32 v6, s54, v4
    v_add_u32 v7, s55, v4
    v_and_b32 v171, 31, v1
    s_and_b32 s54, s5, 1
    s_lshl_b32 s54, s54, 2
    s_add_u32 s54, s54, s52
    s_lshl_b32 s54, s54, 10
    s_lshl_b32 s55, s4, 14
    s_add_u32 s54, s54, s55
    s_lshr_b32 s55, s5, 1
    s_lshl_b32 s55, s55, 18
    s_add_u32 s54, s54, s55
    s_lshl_b32 s55, s54, 1
    s_add_u32 s55, s55, s37
    s_add_u32 s55, s55, 6291456
    s_lshl_b32 s59, s52, 7
    s_add_u32 s59, s59, 152576
    s_cmp_eq_u32 s53, 1
    s_cbranch_scc1 L_interleave_layers__softmax_full_mha__moe_arch_mod__prompt_k1w_40
    s_cmp_lg_u32 s7, 0
    s_cbranch_scc1 L_interleave_layers__softmax_full_mha__moe_arch_mod__prompt_l0_43
    s_mov_b32 s63, 200000
L_interleave_layers__softmax_full_mha__moe_arch_mod__prompt_sp_44:
    ds_read_b32 v183, v180 offset:48
    s_waitcnt lgkmcnt(0)
    v_readfirstlane_b32 s60, v183
    s_nop 0
    s_cmp_ge_u32 s60, 8
    s_cbranch_scc1 L_interleave_layers__softmax_full_mha__moe_arch_mod__prompt_spd_45
    s_sleep 1
    s_sub_u32 s63, s63, 1
    s_cmp_lg_u32 s63, 0
    s_cbranch_scc1 L_interleave_layers__softmax_full_mha__moe_arch_mod__prompt_sp_44
L_interleave_layers__softmax_full_mha__moe_arch_mod__prompt_spd_45:
    v_lshlrev_b32 v2, 5, v1
    v_add_u32 v2, 147456, v2
    ds_read_b128 v[128:131], v2
    ds_read_b128 v[132:135], v2 offset:16
    ds_read_b128 v[136:139], v2 offset:1024
    ds_read_b128 v[140:143], v2 offset:1040
    v_lshlrev_b32 v2, 2, v1
    v_add_u32 v2, 159744, v2
    s_waitcnt lgkmcnt(0)
    v_add_f32 v128, v128, v129
    v_add_f32 v130, v130, v131
    v_add_f32 v132, v132, v133
    v_add_f32 v134, v134, v135
    v_add_f32 v136, v136, v137
    v_add_f32 v138, v138, v139
    v_add_f32 v140, v140, v141
    v_add_f32 v142, v142, v143
    v_add_f32 v128, v128, v130
    v_add_f32 v132, v132, v134
    v_add_f32 v136, v136, v138
    v_add_f32 v140, v140, v142
    v_add_f32 v128, v128, v132
    v_add_f32 v136, v136, v140
    ds_write_b32 v2, v128
    ds_write_b32 v2, v136 offset:128
L_interleave_layers__softmax_full_mha__moe_arch_mod__prompt_l0_43:
    v_lshrrev_b32 v3, 5, v1
    v_lshl_add_u32 v2, v3, 4, s59
    v_lshlrev_b32 v8, 2, v171
    v_add_u32 v9, 160000, v8
    ds_read_b32 v14, v9
    ds_read_b128 v[16:19], v2 offset:0
    ds_read_b128 v[20:23], v2 offset:32
    ds_read_b128 v[24:27], v2 offset:64
    ds_read_b128 v[28:31], v2 offset:96
    ds_read_b128 v[32:35], v2 offset:512
    ds_read_b128 v[36:39], v2 offset:544
    ds_read_b128 v[40:43], v2 offset:576
    ds_read_b128 v[44:47], v2 offset:608
    v_add_u32 v8, s59, v8
    ds_read2st64_b32 v[12:13], v8 offset0:0 offset1:2
    v_lshlrev_b32 v2, 4, v3
    v_add_u32 v2, 159744, v2
    s_waitcnt lgkmcnt(1)
    ds_read_b128 v[64:67], v2 offset:128
    ds_read_b128 v[68:71], v2 offset:160
    ds_read_b128 v[72:75], v2 offset:192
    ds_read_b128 v[76:79], v2 offset:224
    ds_read_b128 v[48:51], v2 offset:0
    ds_read_b128 v[52:55], v2 offset:32
    ds_read_b128 v[56:59], v2 offset:64
    ds_read_b128 v[60:63], v2 offset:96
    v_mul_f32 v32, v32, v14
    v_fma_f32 v112, v16, v112, -v32
    v_mul_f32 v33, v33, v14
    v_fma_f32 v113, v17, v113, -v33
    v_mul_f32 v34, v34, v14
    v_fma_f32 v114, v18, v114, -v34
    v_mul_f32 v35, v35, v14
    v_fma_f32 v115, v19, v115, -v35
    ds_write_b128 v6, v[112:115] offset:0
    v_mul_f32 v36, v36, v14
    v_fma_f32 v116, v20, v116, -v36
    v_mul_f32 v37, v37, v14
    v_fma_f32 v117, v21, v117, -v37
    v_mul_f32 v38, v38, v14
    v_fma_f32 v118, v22, v118, -v38
    v_mul_f32 v39, v39, v14
    v_fma_f32 v119, v23, v119, -v39
    ds_write_b128 v6, v[116:119] offset:1024
    v_mul_f32 v40, v40, v14
    v_fma_f32 v120, v24, v120, -v40
    v_mul_f32 v41, v41, v14
    v_fma_f32 v121, v25, v121, -v41
    v_mul_f32 v42, v42, v14
    v_fma_f32 v122, v26, v122, -v42
    v_mul_f32 v43, v43, v14
    v_fma_f32 v123, v27, v123, -v43
    ds_write_b128 v6, v[120:123] offset:2048
    v_mul_f32 v44, v44, v14
    v_fma_f32 v124, v28, v124, -v44
    v_mul_f32 v45, v45, v14
    v_fma_f32 v125, v29, v125, -v45
    v_mul_f32 v46, v46, v14
    v_fma_f32 v126, v30, v126, -v46
    v_mul_f32 v47, v47, v14
    v_fma_f32 v127, v31, v127, -v47
    ds_write_b128 v6, v[124:127] offset:3072
    v_and_b32 v6, 0x33, v1
    v_and_b32 v3, 4, v1
    v_lshl_add_u32 v6, v3, 1, v6
    v_bfe_u32 v3, v1, 3, 1
    v_lshl_add_u32 v6, v3, 2, v6
    v_lshlrev_b32 v6, 4, v6
    s_add_u32 s56, s54, s36
    s_add_u32 s56, s56, 2097152
    s_add_u32 s57, s56, 0x2000
    s_add_u32 s58, s55, 0x4000
    s_waitcnt lgkmcnt(4)
    v_mul_f32 v10, 1052289595, v12
    v_mul_f32 v11, 1052289595, v13
    v_mul_f32 v64, v13, v64
    v_fma_f32 v96, v12, v96, -v64
    v_mul_f32 v65, v13, v65
    v_fma_f32 v97, v12, v97, -v65
    v_mul_f32 v66, v13, v66
    v_fma_f32 v98, v12, v98, -v66
    v_mul_f32 v67, v13, v67
    v_fma_f32 v99, v12, v99, -v67
    v_mul_f32 v68, v13, v68
    v_fma_f32 v100, v12, v100, -v68
    v_mul_f32 v69, v13, v69
    v_fma_f32 v101, v12, v101, -v69
    v_mul_f32 v70, v13, v70
    v_fma_f32 v102, v12, v102, -v70
    v_mul_f32 v71, v13, v71
    v_fma_f32 v103, v12, v103, -v71
    v_mul_f32 v72, v13, v72
    v_fma_f32 v104, v12, v104, -v72
    v_mul_f32 v73, v13, v73
    v_fma_f32 v105, v12, v105, -v73
    v_mul_f32 v74, v13, v74
    v_fma_f32 v106, v12, v106, -v74
    v_mul_f32 v75, v13, v75
    v_fma_f32 v107, v12, v107, -v75
    v_mul_f32 v76, v13, v76
    v_fma_f32 v108, v12, v108, -v76
    v_mul_f32 v77, v13, v77
    v_fma_f32 v109, v12, v109, -v77
    v_mul_f32 v78, v13, v78
    v_fma_f32 v110, v12, v110, -v78
    v_mul_f32 v79, v13, v79
    v_fma_f32 v111, v12, v111, -v79
    v_mul_f32 v48, v11, v48
    v_fma_f32 v80, v10, v80, -v48
    v_mul_f32 v49, v11, v49
    v_fma_f32 v81, v10, v81, -v49
    v_mul_f32 v50, v11, v50
    v_fma_f32 v82, v10, v82, -v50
    v_mul_f32 v51, v11, v51
    v_fma_f32 v83, v10, v83, -v51
    v_mul_f32 v52, v11, v52
    v_fma_f32 v84, v10, v84, -v52
    v_mul_f32 v53, v11, v53
    v_fma_f32 v85, v10, v85, -v53
    v_mul_f32 v54, v11, v54
    v_fma_f32 v86, v10, v86, -v54
    v_mul_f32 v55, v11, v55
    v_fma_f32 v87, v10, v87, -v55
    v_mul_f32 v56, v11, v56
    v_fma_f32 v88, v10, v88, -v56
    v_mul_f32 v57, v11, v57
    v_fma_f32 v89, v10, v89, -v57
    v_mul_f32 v58, v11, v58
    v_fma_f32 v90, v10, v90, -v58
    v_mul_f32 v59, v11, v59
    v_fma_f32 v91, v10, v91, -v59
    v_mul_f32 v60, v11, v60
    v_fma_f32 v92, v10, v92, -v60
    v_mul_f32 v61, v11, v61
    v_fma_f32 v93, v10, v93, -v61
    v_mul_f32 v62, v11, v62
    v_fma_f32 v94, v10, v94, -v62
    v_mul_f32 v63, v11, v63
    v_fma_f32 v95, v10, v95, -v63
    s_waitcnt lgkmcnt(0)
    s_barrier
    ds_read_b128 v[32:35], v7 offset:4096
    ds_read_b128 v[36:39], v7 offset:5120
    ds_read_b128 v[40:43], v7 offset:6144
    ds_read_b128 v[44:47], v7 offset:7168
    ds_read_b128 v[16:19], v7 offset:0
    ds_read_b128 v[20:23], v7 offset:1024
    ds_read_b128 v[24:27], v7 offset:2048
    ds_read_b128 v[28:31], v7 offset:3072
    s_waitcnt lgkmcnt(6)
    v_fma_f32 v96, v12, v32, v96
    v_fma_f32 v97, v12, v33, v97
    v_fma_f32 v98, v12, v34, v98
    v_fma_f32 v99, v12, v35, v99
    v_fma_f32 v100, v12, v36, v100
    v_fma_f32 v101, v12, v37, v101
    v_fma_f32 v102, v12, v38, v102
    v_fma_f32 v103, v12, v39, v103
    v_cvt_pk_bf16_f32 v136, v96, v97
    v_cvt_pk_bf16_f32 v137, v98, v99
    v_cvt_pk_bf16_f32 v138, v100, v101
    v_cvt_pk_bf16_f32 v139, v102, v103
    buffer_store_dwordx4 v[136:139], v6, s[16:19], s55 offen sc1
    s_waitcnt lgkmcnt(4)
    v_fma_f32 v104, v12, v40, v104
    v_fma_f32 v105, v12, v41, v105
    v_fma_f32 v106, v12, v42, v106
    v_fma_f32 v107, v12, v43, v107
    v_fma_f32 v108, v12, v44, v108
    v_fma_f32 v109, v12, v45, v109
    v_fma_f32 v110, v12, v46, v110
    v_fma_f32 v111, v12, v47, v111
    v_cvt_pk_bf16_f32 v140, v104, v105
    v_cvt_pk_bf16_f32 v141, v106, v107
    v_cvt_pk_bf16_f32 v142, v108, v109
    v_cvt_pk_bf16_f32 v143, v110, v111
    buffer_store_dwordx4 v[140:143], v6, s[16:19], s58 offen sc1
    s_waitcnt lgkmcnt(2)
    v_fma_f32 v80, v10, v16, v80
    v_fma_f32 v81, v10, v17, v81
    v_fma_f32 v82, v10, v18, v82
    v_fma_f32 v83, v10, v19, v83
    v_fma_f32 v84, v10, v20, v84
    v_fma_f32 v85, v10, v21, v85
    v_fma_f32 v86, v10, v22, v86
    v_fma_f32 v87, v10, v23, v87
    v_cvt_pk_bf16_f32 v128, v80, v81
    v_cvt_pk_bf16_f32 v129, v82, v83
    v_cvt_pk_bf16_f32 v130, v84, v85
    v_cvt_pk_bf16_f32 v131, v86, v87
    buffer_store_dwordx4 v[128:131], v4, s[16:19], s56 offen sc1
    s_waitcnt lgkmcnt(0)
    v_fma_f32 v88, v10, v24, v88
    v_fma_f32 v89, v10, v25, v89
    v_fma_f32 v90, v10, v26, v90
    v_fma_f32 v91, v10, v27, v91
    v_fma_f32 v92, v10, v28, v92
    v_fma_f32 v93, v10, v29, v93
    v_fma_f32 v94, v10, v30, v94
    v_fma_f32 v95, v10, v31, v95
    v_cvt_pk_bf16_f32 v132, v88, v89
    v_cvt_pk_bf16_f32 v133, v90, v91
    v_cvt_pk_bf16_f32 v134, v92, v93
    v_cvt_pk_bf16_f32 v135, v94, v95
    buffer_store_dwordx4 v[132:135], v4, s[16:19], s57 offen sc1
    s_branch L_interleave_layers__softmax_full_mha__moe_arch_mod__prompt_gdone_42
L_interleave_layers__softmax_full_mha__moe_arch_mod__prompt_k1w_40:
    s_nop 1
    ds_write_b128 v7, v[96:99] offset:4096
    ds_write_b128 v7, v[100:103] offset:5120
    ds_write_b128 v7, v[104:107] offset:6144
    ds_write_b128 v7, v[108:111] offset:7168
    ds_write_b128 v7, v[80:83] offset:0
    ds_write_b128 v7, v[84:87] offset:1024
    ds_write_b128 v7, v[88:91] offset:2048
    ds_write_b128 v7, v[92:95] offset:3072
    v_lshrrev_b32 v3, 5, v1
    v_lshl_add_u32 v2, v3, 4, s59
    v_bfe_u32 v7, v1, 4, 1
    v_lshlrev_b32 v7, 14, v7
    v_lshl_add_u32 v7, v3, 9, v7
    v_and_b32 v3, 15, v1
    v_lshl_add_u32 v7, v3, 4, v7
    s_waitcnt lgkmcnt(0)
    s_barrier
    ds_read_b128 v[32:35], v2 offset:0
    ds_read_b128 v[16:19], v6 offset:0
    ds_read_b128 v[36:39], v2 offset:32
    ds_read_b128 v[20:23], v6 offset:1024
    ds_read_b128 v[40:43], v2 offset:64
    ds_read_b128 v[24:27], v6 offset:2048
    ds_read_b128 v[44:47], v2 offset:96
    ds_read_b128 v[28:31], v6 offset:3072
    s_waitcnt lgkmcnt(4)
    v_fma_f32 v112, v32, v112, v16
    v_fma_f32 v113, v33, v113, v17
    v_fma_f32 v114, v34, v114, v18
    v_fma_f32 v115, v35, v115, v19
    v_fma_f32 v116, v36, v116, v20
    v_fma_f32 v117, v37, v117, v21
    v_fma_f32 v118, v38, v118, v22
    v_fma_f32 v119, v39, v119, v23
    v_cvt_pk_bf16_f32 v128, v112, v113
    v_cvt_pk_bf16_f32 v129, v114, v115
    v_cvt_pk_bf16_f32 v130, v116, v117
    v_cvt_pk_bf16_f32 v131, v118, v119
    buffer_store_dwordx4 v[128:131], v7, s[16:19], s55 offen offset:1024 sc1
    s_waitcnt lgkmcnt(0)
    v_fma_f32 v120, v40, v120, v24
    v_fma_f32 v121, v41, v121, v25
    v_fma_f32 v122, v42, v122, v26
    v_fma_f32 v123, v43, v123, v27
    v_fma_f32 v124, v44, v124, v28
    v_fma_f32 v125, v45, v125, v29
    v_fma_f32 v126, v46, v126, v30
    v_fma_f32 v127, v47, v127, v31
    v_cvt_pk_bf16_f32 v132, v120, v121
    v_cvt_pk_bf16_f32 v133, v122, v123
    v_cvt_pk_bf16_f32 v134, v124, v125
    v_cvt_pk_bf16_f32 v135, v126, v127
    buffer_store_dwordx4 v[132:135], v7, s[16:19], s55 offen offset:1280 sc1
L_interleave_layers__softmax_full_mha__moe_arch_mod__prompt_gdone_42:
    s_lshl_b32 s54, s4, 11
    s_lshl_b32 s55, s5, 2
    s_add_u32 s54, s54, s55
    s_lshl_b32 s55, s7, 15
    s_add_u32 s54, s54, s55
    s_add_u32 s54, s54, 20971520
    v_mov_b32 v2, s3
    v_lshlrev_b32 v3, 7, v1
    s_waitcnt vmcnt(0) lgkmcnt(0)
    s_barrier
    s_cmp_lg_u32 s6, 0
    s_cbranch_scc1 L_interleave_layers__softmax_full_mha__moe_arch_mod__prompt_fl_46
    s_mov_b64 exec, 0xffff
    buffer_store_dword v2, v3, s[16:19], s54 offen sc1
    s_mov_b64 exec, -1
L_interleave_layers__softmax_full_mha__moe_arch_mod__prompt_fl_46:
    s_cmp_lg_u32 s7, 0
    s_cbranch_scc1 L_interleave_layers__softmax_full_mha__moe_arch_mod__prompt_l0_47
    v_mov_b32 v164, 0
    v_add_u32 v2, 162816, v4
    ds_write_b128 v2, v[232:235]
    v_dot2c_f32_bf16 v164, s34, v232
    v_dot2c_f32_bf16 v164, s34, v233
    v_dot2c_f32_bf16 v164, s34, v234
    v_dot2c_f32_bf16 v164, s34, v235
    s_nop 2
    v_add_f32_dpp v164, v164, v164 row_shr:1 row_mask:0xf bank_mask:0xf
    s_nop 1
    v_add_f32_dpp v164, v164, v164 row_shr:2 row_mask:0xf bank_mask:0xf
    s_nop 1
    v_add_f32_dpp v164, v164, v164 row_shr:4 row_mask:0xf bank_mask:0xf
    s_nop 1
    v_add_f32_dpp v164, v164, v164 row_shr:8 row_mask:0xf bank_mask:0xf
    s_nop 1
    v_add_f32_dpp v164, v164, v164 row_bcast:15 row_mask:0xa bank_mask:0xf
    s_nop 1
    v_add_f32_dpp v164, v164, v164 row_bcast:31 row_mask:0xc bank_mask:0xf
    s_nop 0
    v_readlane_b32 s28, v164, 63
L_interleave_layers__softmax_full_mha__moe_arch_mod__prompt_l0_47:
    s_cmp_lg_u32 s7, 0
    s_cbranch_scc1 L_interleave_layers__softmax_full_mha__moe_arch_mod__prompt_l0_48
    s_lshl_b32 s52, s6, 10
    v_add_u32 v2, s52, v4
    v_add_u32 v3, 0x10000, v2
    ds_read_b128 v[144:147], v2 offset:0
    ds_read_b128 v[148:151], v2 offset:8192
    ds_read_b128 v[152:155], v2 offset:16384
    ds_read_b128 v[156:159], v2 offset:24576
    ds_read_b128 v[160:163], v2 offset:32768
    ds_read_b128 v[164:167], v2 offset:40960
    ds_read_b128 v[168:171], v2 offset:49152
    ds_read_b128 v[172:175], v2 offset:57344
    ds_read_b128 v[176:179], v3 offset:0
    ds_read_b128 v[180:183], v3 offset:8192
    ds_read_b128 v[184:187], v3 offset:16384
    ds_read_b128 v[188:191], v3 offset:24576
L_interleave_layers__softmax_full_mha__moe_arch_mod__prompt_l0_48:
    s_cmp_eq_u32 s7, 0
    s_cbranch_scc1 L_interleave_layers__softmax_full_mha__moe_arch_mod__prompt_b_49
    s_cmp_lg_u32 s6, 7
    s_cbranch_scc1 L_interleave_layers__softmax_full_mha__moe_arch_mod__prompt_b_49
    s_call_b64 s[90:91], L_getkey
L_interleave_layers__softmax_full_mha__moe_arch_mod__prompt_b_49:
    s_mov_b32 s43, s84
    s_and_b32 s41, s6, 1
    v_mov_b32 v5, 0xdddddddd
    v_mov_b32 v2, 1065369472
    v_and_b32 v3, 27, v1
    v_cmp_eq_u32 vcc, 16, v3
    s_nop 1
    v_cndmask_b32 v2, 0, v2, vcc
    v_mov_b32 v84, v2
    v_mov_b32 v85, v2
    v_mov_b32 v86, v2
    v_mov_b32 v87, v2
    v_mov_b32 v88, v2
    v_mov_b32 v89, v2
    v_mov_b32 v90, v2
    v_mov_b32 v91, v2
    v_mov_b32 v92, v2
    v_mov_b32 v93, v2
    v_mov_b32 v94, v2
    v_mov_b32 v95, v2
    v_mov_b32 v96, v2
    v_mov_b32 v97, v2
    v_mov_b32 v98, v2
    v_mov_b32 v99, v2
    v_mov_b32 v48, 0
    v_mov_b32 v49, 0
    v_mov_b32 v50, 0
    v_mov_b32 v51, 0
    v_mov_b32 v52, 0
    v_mov_b32 v53, 0
    v_mov_b32 v54, 0
    v_mov_b32 v55, 0
    v_mov_b32 v56, 0
    v_mov_b32 v57, 0
    v_mov_b32 v58, 0
    v_mov_b32 v59, 0
    v_mov_b32 v60, 0
    v_mov_b32 v61, 0
    v_mov_b32 v62, 0
    v_mov_b32 v63, 0
    v_mov_b32 v64, 0
    v_mov_b32 v65, 0
    v_mov_b32 v66, 0
    v_mov_b32 v67, 0
    v_mov_b32 v68, 0
    v_mov_b32 v69, 0
    v_mov_b32 v70, 0
    v_mov_b32 v71, 0
    v_mov_b32 v72, 0
    v_mov_b32 v73, 0
    v_mov_b32 v74, 0
    v_mov_b32 v75, 0
    v_mov_b32 v76, 0
    v_mov_b32 v77, 0
    v_mov_b32 v78, 0
    v_mov_b32 v79, 0
    v_mov_b32 v108, 0
    v_mov_b32 v109, 0
    v_mov_b32 v110, 0
    v_mov_b32 v111, 0
    v_mov_b32 v112, 0
    v_mov_b32 v113, 0
    v_mov_b32 v114, 0
    v_mov_b32 v115, 0
    v_mov_b32 v116, 0
    v_mov_b32 v117, 0
    v_mov_b32 v118, 0
    v_mov_b32 v119, 0
    v_mov_b32 v120, 0
    v_mov_b32 v121, 0
    v_mov_b32 v122, 0
    v_mov_b32 v123, 0
    v_mov_b32 v40, 0
    v_mov_b32 v41, 0
    v_mov_b32 v42, 0
    v_mov_b32 v43, 0
    v_mov_b32 v44, 0
    v_mov_b32 v45, 0
    v_mov_b32 v46, 0
    v_mov_b32 v47, 0
    s_lshl_b32 s47, s43, 13
    s_add_u32 s47, s47, s36
    s_and_b32 s52, s4, 7
    s_lshl_b32 s52, s52, 18
    s_add_u32 s47, s47, s52
    s_add_u32 s47, s47, 2097152
    s_lshl_b32 s48, s43, 14
    s_add_u32 s48, s48, s37
    s_add_u32 s48, s48, 6291456
    s_lshl_b32 s45, s41, 16
    v_add_u32 v7, s45, v4
    s_mul_i32 s88, s7, s30
    s_lshl_b32 s54, s7, 15
    s_add_u32 s54, s54, 20971520
    s_cmp_lg_u32 s6, 0
    s_cbranch_scc1 L_interleave_layers__softmax_full_mha__moe_arch_mod__prompt_wp_50
    s_lshl_b32 s60, s5, 11
    s_lshl_b32 s61, s4, 7
    s_add_u32 s62, s60, s61
    s_add_u32 s62, s62, s54
    v_lshlrev_b32 v2, 2, v1
    s_mov_b64 exec, 0xffff
    s_mov_b32 s63, 200000
L_interleave_layers__softmax_full_mha__moe_arch_mod__prompt_poll_51:
    buffer_load_dword v3, v2, s[16:19], s62 offen sc1
    s_waitcnt vmcnt(0)
L_interleave_layers__softmax_full_mha__moe_arch_mod__prompt_pollc_53:
    v_cmp_ne_u32 vcc, s3, v3
    s_cbranch_vccz L_interleave_layers__softmax_full_mha__moe_arch_mod__prompt_polld_52
    s_sleep 1
    s_sub_u32 s63, s63, 1
    s_cmp_lg_u32 s63, 0
    s_cbranch_scc1 L_interleave_layers__softmax_full_mha__moe_arch_mod__prompt_poll_51
L_interleave_layers__softmax_full_mha__moe_arch_mod__prompt_polld_52:
    s_mov_b64 exec, -1
L_interleave_layers__softmax_full_mha__moe_arch_mod__prompt_wp_50:
    s_waitcnt lgkmcnt(0)
    s_barrier
    s_mov_b32 s62, 1048576
    s_mov_b32 s59, 1703936
    s_cmp_eq_u32 s7, 0
    s_cbranch_scc1 L_interleave_layers__softmax_full_mha__moe_arch_mod__prompt_nosel_54
    s_call_b64 s[90:91], L_getsel
    s_and_b32 s52, s4, 7
    s_lshr_b32 s53, s29, 8
    s_sub_u32 s54, 11, s52
    s_cmp_ge_u32 s52, 6
    s_cselect_b32 s54, s52, s54
    s_cselect_b32 s55, 0, 1
    s_cmp_eq_u32 s53, s54
    s_cselect_b32 s54, 1, 0
    s_cmp_eq_u32 s54, s55
    s_cselect_b32 s54, s88, 0
    s_cmp_ge_u32 s52, 4
    s_cselect_b32 s88, s54, s88
    s_cmp_lg_u32 s88, 1
    s_cbranch_scc1 L_interleave_layers__softmax_full_mha__moe_arch_mod__prompt_nosel_54
    s_call_b64 s[92:93], L_s1a
L_interleave_layers__softmax_full_mha__moe_arch_mod__prompt_nosel_54:
    s_and_b32 s42, s4, 7
    s_lshl_b32 s42, s42, 2
    s_lshr_b32 s52, s6, 1
    s_add_u32 s42, s42, s52
    s_lshr_b32 s53, s29, 6
    s_cmp_eq_u32 s53, s42
    s_cselect_b32 s40, s7, 0
    s_lshl_b32 s42, s42, 1
    s_lshr_b32 s53, s29, 5
    s_cmp_eq_u32 s40, 1
    s_cselect_b32 s42, s53, s42
    s_add_u32 s53, s53, 1
    s_mul_i32 s44, s53, s7
    s_andn2_b32 s53, s41, s40
    s_xor_b32 s42, s42, s53
    s_xor_b32 s52, s42, 1
    s_and_b32 s52, s52, 7
    s_lshl_b32 s52, s52, 10
    s_add_u32 s55, s52, s47
    s_and_b32 s53, s42, 7
    s_lshl_b32 s53, s53, 10
    s_add_u32 s56, s53, s47
    buffer_load_dwordx4 v[104:107], v4, s[16:19], s55 offen sc1
    buffer_load_dwordx4 v[100:103], v4, s[16:19], s56 offen sc1
    s_lshr_b32 s52, s6, 1
    s_and_b32 s53, s6, 1
    s_lshl_b32 s53, s53, 10
    s_lshl_b32 s49, s52, 11
    s_add_u32 s49, s49, s53
    s_lshl_b32 s50, s44, 11
    s_add_u32 s50, s50, s49
    s_add_u32 m0, s49, 0
    s_add_u32 s55, s50, 0
    s_and_b32 s54, s55, 0x1c000
    s_and_b32 s55, s55, 0x3fff
    s_lshl_b32 s54, s54, 5
    s_add_u32 s55, s55, s48
    s_add_u32 s55, s55, s54
    buffer_load_dwordx4 v4, s[16:19], s55 offen sc1 lds
    s_add_u32 m0, s49, 65536
    s_add_u32 s55, s50, 65536
    s_and_b32 s54, s55, 0x1c000
    s_and_b32 s55, s55, 0x3fff
    s_lshl_b32 s54, s54, 5
    s_add_u32 s55, s55, s48
    s_add_u32 s55, s55, s54
    buffer_load_dwordx4 v4, s[16:19], s55 offen sc1 lds
    s_add_u32 m0, s49, 8192
    s_add_u32 s55, s50, 8192
    s_and_b32 s54, s55, 0x1c000
    s_and_b32 s55, s55, 0x3fff
    s_lshl_b32 s54, s54, 5
    s_add_u32 s55, s55, s48
    s_add_u32 s55, s55, s54
    buffer_load_dwordx4 v4, s[16:19], s55 offen sc1 lds
    s_add_u32 m0, s49, 73728
    s_add_u32 s55, s50, 73728
    s_and_b32 s54, s55, 0x1c000
    s_and_b32 s55, s55, 0x3fff
    s_lshl_b32 s54, s54, 5
    s_add_u32 s55, s55, s48
    s_add_u32 s55, s55, s54
    buffer_load_dwordx4 v4, s[16:19], s55 offen sc1 lds
    s_cmp_lg_u32 s88, 1
    s_cbranch_scc1 L_interleave_layers__softmax_full_mha__moe_arch_mod__prompt_ro_55
    s_waitcnt vmcnt(6)
    s_call_b64 s[92:93], L_s1b
L_interleave_layers__softmax_full_mha__moe_arch_mod__prompt_ro_55:
    s_waitcnt vmcnt(0)
    s_barrier
    s_cmp_lg_u32 s88, 1
    s_cbranch_scc1 L_interleave_layers__softmax_full_mha__moe_arch_mod__prompt_ro_56
    s_call_b64 s[92:93], L_s1c
L_interleave_layers__softmax_full_mha__moe_arch_mod__prompt_ro_56:
    s_cmp_lt_u32 s6, 4
    s_cbranch_scc1 L_interleave_layers__softmax_full_mha__moe_arch_mod__prompt_pr_57
    s_setprio 1
L_interleave_layers__softmax_full_mha__moe_arch_mod__prompt_pr_57:
    s_cmp_eq_u32 s40, 1
    s_cbranch_scc1 L_interleave_layers__softmax_full_mha__moe_arch_mod__prompt_up_58
    ds_read_b128 v[80:83], v7 offset:0
    s_mov_b64 exec, s[32:33]
    ds_read_b128 v[84:87], v7 offset:1024
    ds_read_b128 v[88:91], v7 offset:1280
    s_mov_b64 exec, -1
    s_waitcnt lgkmcnt(2)
    v_mfma_f32_32x32x16_bf16 v[16:31], v[80:83], v[100:103], 0
    s_nop 11
    v_exp_f32 v16, v16
    v_exp_f32 v17, v17
    v_smfmac_f32_32x32x32_bf16 v[64:79], v[96:99], v[40:47], v5
    s_mov_b64 exec, s[32:33]
    ds_read_b128 v[92:95], v7 offset:3072
    ds_read_b128 v[96:99], v7 offset:3328
    s_mov_b64 exec, -1
    v_exp_f32 v18, v18
    v_exp_f32 v19, v19
    v_exp_f32 v20, v20
    v_exp_f32 v21, v21
    v_exp_f32 v22, v22
    v_mfma_f32_32x32x16_bf16 v[32:47], v[80:83], v[104:107], 0
    ds_read_b128 v[80:83], v7 offset:2048
    v_exp_f32 v23, v23
    v_exp_f32 v24, v24
    v_exp_f32 v25, v25
    v_exp_f32 v26, v26
    v_exp_f32 v27, v27
    s_waitcnt lgkmcnt(3)
    v_smfmac_f32_32x32x32_bf16 v[48:63], v[84:87], v[16:23], v5
    s_add_u32 m0, s49, 16384
    s_add_u32 s55, s50, 16384
    s_and_b32 s54, s55, 0x1c000
    s_and_b32 s55, s55, 0x3fff
    s_lshl_b32 s54, s54, 5
    s_add_u32 s55, s55, s48
    s_add_u32 s55, s55, s54
    buffer_load_dwordx4 v4, s[16:19], s55 offen sc1 lds
    v_exp_f32 v28, v28
    v_exp_f32 v29, v29
    v_exp_f32 v30, v30
    v_exp_f32 v31, v31
    v_exp_f32 v32, v32
    v_exp_f32 v33, v33
    v_smfmac_f32_32x32x32_bf16 v[48:63], v[88:91], v[24:31], v5
    v_exp_f32 v34, v34
    v_exp_f32 v35, v35
    v_exp_f32 v36, v36
    v_exp_f32 v37, v37
    v_exp_f32 v38, v38
    s_waitcnt lgkmcnt(0)
    v_mfma_f32_32x32x16_bf16 v[16:31], v[80:83], v[100:103], 0
    v_exp_f32 v39, v39
    v_exp_f32 v40, v40
    v_exp_f32 v41, v41
    v_exp_f32 v42, v42
    v_exp_f32 v43, v43
    v_smfmac_f32_32x32x32_bf16 v[64:79], v[84:87], v[32:39], v5
    s_add_u32 m0, s49, 81920
    s_add_u32 s55, s50, 81920
    s_and_b32 s54, s55, 0x1c000
    s_and_b32 s55, s55, 0x3fff
    s_lshl_b32 s54, s54, 5
    s_add_u32 s55, s55, s48
    s_add_u32 s55, s55, s54
    buffer_load_dwordx4 v4, s[16:19], s55 offen sc1 lds
    v_exp_f32 v44, v44
    v_exp_f32 v45, v45
    v_exp_f32 v46, v46
    v_exp_f32 v47, v47
    v_exp_f32 v16, v16
    v_exp_f32 v17, v17
    v_smfmac_f32_32x32x32_bf16 v[64:79], v[88:91], v[40:47], v5
    s_mov_b64 exec, s[32:33]
    ds_read_b128 v[84:87], v7 offset:5120
    ds_read_b128 v[88:91], v7 offset:5376
    s_mov_b64 exec, -1
    v_exp_f32 v18, v18
    v_exp_f32 v19, v19
    v_exp_f32 v20, v20
    v_exp_f32 v21, v21
    v_exp_f32 v22, v22
    v_mfma_f32_32x32x16_bf16 v[32:47], v[80:83], v[104:107], 0
    ds_read_b128 v[80:83], v7 offset:4096
    v_exp_f32 v23, v23
    v_exp_f32 v24, v24
    v_exp_f32 v25, v25
    v_exp_f32 v26, v26
    v_exp_f32 v27, v27
    s_waitcnt lgkmcnt(3)
    v_smfmac_f32_32x32x32_bf16 v[48:63], v[92:95], v[16:23], v5
    s_add_u32 m0, s49, 24576
    s_add_u32 s55, s50, 24576
    s_and_b32 s54, s55, 0x1c000
    s_and_b32 s55, s55, 0x3fff
    s_lshl_b32 s54, s54, 5
    s_add_u32 s55, s55, s48
    s_add_u32 s55, s55, s54
    buffer_load_dwordx4 v4, s[16:19], s55 offen sc1 lds
    v_exp_f32 v28, v28
    v_exp_f32 v29, v29
    v_exp_f32 v30, v30
    v_exp_f32 v31, v31
    v_exp_f32 v32, v32
    v_exp_f32 v33, v33
    v_smfmac_f32_32x32x32_bf16 v[48:63], v[96:99], v[24:31], v5
    v_exp_f32 v34, v34
    v_exp_f32 v35, v35
    v_exp_f32 v36, v36
    v_exp_f32 v37, v37
    v_exp_f32 v38, v38
    s_waitcnt lgkmcnt(0)
    v_mfma_f32_32x32x16_bf16 v[16:31], v[80:83], v[100:103], 0
    v_exp_f32 v39, v39
    v_exp_f32 v40, v40
    v_exp_f32 v41, v41
    v_exp_f32 v42, v42
    v_exp_f32 v43, v43
    v_smfmac_f32_32x32x32_bf16 v[64:79], v[92:95], v[32:39], v5
    s_add_u32 m0, s49, 90112
    s_add_u32 s55, s50, 90112
    s_and_b32 s54, s55, 0x1c000
    s_and_b32 s55, s55, 0x3fff
    s_lshl_b32 s54, s54, 5
    s_add_u32 s55, s55, s48
    s_add_u32 s55, s55, s54
    buffer_load_dwordx4 v4, s[16:19], s55 offen sc1 lds
    v_exp_f32 v44, v44
    v_exp_f32 v45, v45
    v_exp_f32 v46, v46
    v_exp_f32 v47, v47
    v_exp_f32 v16, v16
    v_exp_f32 v17, v17
    v_smfmac_f32_32x32x32_bf16 v[64:79], v[96:99], v[40:47], v5
    s_mov_b64 exec, s[32:33]
    ds_read_b128 v[92:95], v7 offset:7168
    ds_read_b128 v[96:99], v7 offset:7424
    s_mov_b64 exec, -1
    v_exp_f32 v18, v18
    v_exp_f32 v19, v19
    v_exp_f32 v20, v20
    v_exp_f32 v21, v21
    v_exp_f32 v22, v22
    v_mfma_f32_32x32x16_bf16 v[32:47], v[80:83], v[104:107], 0
    ds_read_b128 v[80:83], v7 offset:6144
    v_exp_f32 v23, v23
    v_exp_f32 v24, v24
    v_exp_f32 v25, v25
    v_exp_f32 v26, v26
    v_exp_f32 v27, v27
    s_waitcnt lgkmcnt(3)
    v_smfmac_f32_32x32x32_bf16 v[48:63], v[84:87], v[16:23], v5
    s_add_u32 m0, s49, 32768
    s_add_u32 s55, s50, 32768
    s_and_b32 s54, s55, 0x1c000
    s_and_b32 s55, s55, 0x3fff
    s_lshl_b32 s54, s54, 5
    s_add_u32 s55, s55, s48
    s_add_u32 s55, s55, s54
    buffer_load_dwordx4 v4, s[16:19], s55 offen sc1 lds
    v_exp_f32 v28, v28
    v_exp_f32 v29, v29
    v_exp_f32 v30, v30
    v_exp_f32 v31, v31
    v_exp_f32 v32, v32
    v_exp_f32 v33, v33
    v_smfmac_f32_32x32x32_bf16 v[48:63], v[88:91], v[24:31], v5
    v_exp_f32 v34, v34
    v_exp_f32 v35, v35
    v_exp_f32 v36, v36
    v_exp_f32 v37, v37
    v_exp_f32 v38, v38
    s_waitcnt lgkmcnt(0)
    v_mfma_f32_32x32x16_bf16 v[16:31], v[80:83], v[100:103], 0
    v_exp_f32 v39, v39
    v_exp_f32 v40, v40
    v_exp_f32 v41, v41
    v_exp_f32 v42, v42
    v_exp_f32 v43, v43
    v_smfmac_f32_32x32x32_bf16 v[64:79], v[84:87], v[32:39], v5
    s_add_u32 m0, s49, 98304
    s_add_u32 s55, s50, 98304
    s_and_b32 s54, s55, 0x1c000
    s_and_b32 s55, s55, 0x3fff
    s_lshl_b32 s54, s54, 5
    s_add_u32 s55, s55, s48
    s_add_u32 s55, s55, s54
    buffer_load_dwordx4 v4, s[16:19], s55 offen sc1 lds
    v_exp_f32 v44, v44
    v_exp_f32 v45, v45
    v_exp_f32 v46, v46
    v_exp_f32 v47, v47
    s_waitcnt vmcnt(2)
    s_barrier
    v_exp_f32 v16, v16
    v_exp_f32 v17, v17
    v_smfmac_f32_32x32x32_bf16 v[64:79], v[88:91], v[40:47], v5
    s_mov_b64 exec, s[32:33]
    ds_read_b128 v[84:87], v7 offset:9216
    ds_read_b128 v[88:91], v7 offset:9472
    s_mov_b64 exec, -1
    v_exp_f32 v18, v18
    v_exp_f32 v19, v19
    v_exp_f32 v20, v20
    v_exp_f32 v21, v21
    v_exp_f32 v22, v22
    v_mfma_f32_32x32x16_bf16 v[32:47], v[80:83], v[104:107], 0
    ds_read_b128 v[80:83], v7 offset:8192
    v_exp_f32 v23, v23
    v_exp_f32 v24, v24
    v_exp_f32 v25, v25
    v_exp_f32 v26, v26
    v_exp_f32 v27, v27
    s_waitcnt lgkmcnt(3)
    v_smfmac_f32_32x32x32_bf16 v[48:63], v[92:95], v[16:23], v5
    s_add_u32 m0, s49, 40960
    s_add_u32 s55, s50, 40960
    s_and_b32 s54, s55, 0x1c000
    s_and_b32 s55, s55, 0x3fff
    s_lshl_b32 s54, s54, 5
    s_add_u32 s55, s55, s48
    s_add_u32 s55, s55, s54
    buffer_load_dwordx4 v4, s[16:19], s55 offen sc1 lds
    v_exp_f32 v28, v28
    v_exp_f32 v29, v29
    v_exp_f32 v30, v30
    v_exp_f32 v31, v31
    v_exp_f32 v32, v32
    v_exp_f32 v33, v33
    v_smfmac_f32_32x32x32_bf16 v[48:63], v[96:99], v[24:31], v5
    v_exp_f32 v34, v34
    v_exp_f32 v35, v35
    v_exp_f32 v36, v36
    v_exp_f32 v37, v37
    v_exp_f32 v38, v38
    s_waitcnt lgkmcnt(0)
    v_mfma_f32_32x32x16_bf16 v[16:31], v[80:83], v[100:103], 0
    v_exp_f32 v39, v39
    v_exp_f32 v40, v40
    v_exp_f32 v41, v41
    v_exp_f32 v42, v42
    v_exp_f32 v43, v43
    v_smfmac_f32_32x32x32_bf16 v[64:79], v[92:95], v[32:39], v5
    s_add_u32 m0, s49, 106496
    s_add_u32 s55, s50, 106496
    s_and_b32 s54, s55, 0x1c000
    s_and_b32 s55, s55, 0x3fff
    s_lshl_b32 s54, s54, 5
    s_add_u32 s55, s55, s48
    s_add_u32 s55, s55, s54
    buffer_load_dwordx4 v4, s[16:19], s55 offen sc1 lds
    v_exp_f32 v44, v44
    v_exp_f32 v45, v45
    v_exp_f32 v46, v46
    v_exp_f32 v47, v47
    s_cmp_lg_u32 s88, 2
    s_cbranch_scc1 L_interleave_layers__softmax_full_mha__moe_arch_mod__prompt_ro_78
    s_call_b64 s[92:93], L_s2a
L_interleave_layers__softmax_full_mha__moe_arch_mod__prompt_ro_78:
    v_exp_f32 v16, v16
    v_exp_f32 v17, v17
    v_smfmac_f32_32x32x32_bf16 v[64:79], v[96:99], v[40:47], v5
    s_mov_b64 exec, s[32:33]
    ds_read_b128 v[92:95], v7 offset:11264
    ds_read_b128 v[96:99], v7 offset:11520
    s_mov_b64 exec, -1
    v_exp_f32 v18, v18
    v_exp_f32 v19, v19
    v_exp_f32 v20, v20
    v_exp_f32 v21, v21
    v_exp_f32 v22, v22
    v_mfma_f32_32x32x16_bf16 v[32:47], v[80:83], v[104:107], 0
    ds_read_b128 v[80:83], v7 offset:10240
    v_exp_f32 v23, v23
    v_exp_f32 v24, v24
    v_exp_f32 v25, v25
    v_exp_f32 v26, v26
    v_exp_f32 v27, v27
    s_waitcnt lgkmcnt(3)
    v_smfmac_f32_32x32x32_bf16 v[48:63], v[84:87], v[16:23], v5
    s_add_u32 m0, s49, 49152
    s_add_u32 s55, s50, 49152
    s_and_b32 s54, s55, 0x1c000
    s_and_b32 s55, s55, 0x3fff
    s_lshl_b32 s54, s54, 5
    s_add_u32 s55, s55, s48
    s_add_u32 s55, s55, s54
    buffer_load_dwordx4 v4, s[16:19], s55 offen sc1 lds
    s_add_u32 m0, s49, 114688
    s_add_u32 s55, s50, 114688
    s_and_b32 s54, s55, 0x1c000
    s_and_b32 s55, s55, 0x3fff
    s_lshl_b32 s54, s54, 5
    s_add_u32 s55, s55, s48
    s_add_u32 s55, s55, s54
    buffer_load_dwordx4 v4, s[16:19], s55 offen sc1 lds
    v_exp_f32 v28, v28
    v_exp_f32 v29, v29
    v_exp_f32 v30, v30
    v_exp_f32 v31, v31
    v_exp_f32 v32, v32
    v_exp_f32 v33, v33
    v_smfmac_f32_32x32x32_bf16 v[48:63], v[88:91], v[24:31], v5
    v_exp_f32 v34, v34
    v_exp_f32 v35, v35
    v_exp_f32 v36, v36
    v_exp_f32 v37, v37
    v_exp_f32 v38, v38
    s_waitcnt lgkmcnt(0)
    v_mfma_f32_32x32x16_bf16 v[16:31], v[80:83], v[100:103], 0
    v_exp_f32 v39, v39
    v_exp_f32 v40, v40
    v_exp_f32 v41, v41
    v_exp_f32 v42, v42
    v_exp_f32 v43, v43
    v_smfmac_f32_32x32x32_bf16 v[64:79], v[84:87], v[32:39], v5
    s_add_u32 m0, s49, 57344
    s_add_u32 s55, s50, 57344
    s_and_b32 s54, s55, 0x1c000
    s_and_b32 s55, s55, 0x3fff
    s_lshl_b32 s54, s54, 5
    s_add_u32 s55, s55, s48
    s_add_u32 s55, s55, s54
    buffer_load_dwordx4 v4, s[16:19], s55 offen sc1 lds
    s_add_u32 m0, s49, 122880
    s_add_u32 s55, s50, 122880
    s_and_b32 s54, s55, 0x1c000
    s_and_b32 s55, s55, 0x3fff
    s_lshl_b32 s54, s54, 5
    s_add_u32 s55, s55, s48
    s_add_u32 s55, s55, s54
    buffer_load_dwordx4 v4, s[16:19], s55 offen sc1 lds
    v_exp_f32 v44, v44
    v_exp_f32 v45, v45
    v_exp_f32 v46, v46
    v_exp_f32 v47, v47
    s_cmp_lt_u32 s6, 4
    s_cbranch_scc1 L_interleave_layers__softmax_full_mha__moe_arch_mod__prompt_pr_79
    s_setprio 0
L_interleave_layers__softmax_full_mha__moe_arch_mod__prompt_pr_79:
    v_exp_f32 v16, v16
    v_exp_f32 v17, v17
    v_smfmac_f32_32x32x32_bf16 v[64:79], v[88:91], v[40:47], v5
    s_mov_b64 exec, s[32:33]
    ds_read_b128 v[84:87], v7 offset:13312
    ds_read_b128 v[88:91], v7 offset:13568
    s_mov_b64 exec, -1
    v_exp_f32 v18, v18
    v_exp_f32 v19, v19
    v_exp_f32 v20, v20
    v_exp_f32 v21, v21
    v_exp_f32 v22, v22
    v_mfma_f32_32x32x16_bf16 v[32:47], v[80:83], v[104:107], 0
    ds_read_b128 v[80:83], v7 offset:12288
    v_exp_f32 v23, v23
    v_exp_f32 v24, v24
    v_exp_f32 v25, v25
    v_exp_f32 v26, v26
    v_exp_f32 v27, v27
    s_waitcnt lgkmcnt(3)
    v_smfmac_f32_32x32x32_bf16 v[48:63], v[92:95], v[16:23], v5
    v_exp_f32 v28, v28
    v_exp_f32 v29, v29
    v_exp_f32 v30, v30
    v_exp_f32 v31, v31
    v_exp_f32 v32, v32
    v_exp_f32 v33, v33
    v_smfmac_f32_32x32x32_bf16 v[48:63], v[96:99], v[24:31], v5
    v_exp_f32 v34, v34
    v_exp_f32 v35, v35
    v_exp_f32 v36, v36
    v_exp_f32 v37, v37
    v_exp_f32 v38, v38
    s_waitcnt lgkmcnt(0)
    v_mfma_f32_32x32x16_bf16 v[16:31], v[80:83], v[100:103], 0
    v_exp_f32 v39, v39
    v_exp_f32 v40, v40
    v_exp_f32 v41, v41
    v_exp_f32 v42, v42
    v_exp_f32 v43, v43
    v_smfmac_f32_32x32x32_bf16 v[64:79], v[92:95], v[32:39], v5
    v_exp_f32 v44, v44
    v_exp_f32 v45, v45
    v_exp_f32 v46, v46
    v_exp_f32 v47, v47
    s_waitcnt vmcnt(0)
    s_cmp_lg_u32 s88, 2
    s_cbranch_scc1 L_interleave_layers__softmax_full_mha__moe_arch_mod__prompt_ro_80
    s_call_b64 s[92:93], L_s2b
L_interleave_layers__softmax_full_mha__moe_arch_mod__prompt_ro_80:
    s_barrier
    s_cmp_lg_u32 s88, 2
    s_cbranch_scc1 L_interleave_layers__softmax_full_mha__moe_arch_mod__prompt_ro_81
    s_call_b64 s[92:93], L_s2c
L_interleave_layers__softmax_full_mha__moe_arch_mod__prompt_ro_81:
    s_cmp_lt_u32 s6, 4
    s_cbranch_scc1 L_interleave_layers__softmax_full_mha__moe_arch_mod__prompt_pr_82
    s_setprio 1
L_interleave_layers__softmax_full_mha__moe_arch_mod__prompt_pr_82:
    v_exp_f32 v16, v16
    v_exp_f32 v17, v17
    v_smfmac_f32_32x32x32_bf16 v[64:79], v[96:99], v[40:47], v5
    s_mov_b64 exec, s[32:33]
    ds_read_b128 v[92:95], v7 offset:15360
    ds_read_b128 v[96:99], v7 offset:15616
    s_mov_b64 exec, -1
    v_exp_f32 v18, v18
    v_exp_f32 v19, v19
    v_exp_f32 v20, v20
    v_exp_f32 v21, v21
    v_exp_f32 v22, v22
    v_mfma_f32_32x32x16_bf16 v[32:47], v[80:83], v[104:107], 0
    ds_read_b128 v[80:83], v7 offset:14336
    v_exp_f32 v23, v23
    v_exp_f32 v24, v24
    v_exp_f32 v25, v25
    v_exp_f32 v26, v26
    v_exp_f32 v27, v27
    s_waitcnt lgkmcnt(3)
    v_smfmac_f32_32x32x32_bf16 v[48:63], v[84:87], v[16:23], v5
    s_cmp_lg_u32 s7, 0
    s_cbranch_scc1 L_interleave_layers__softmax_full_mha__moe_arch_mod__prompt_pf_69
    s_cmp_lt_u32 s6, 6
    s_cbranch_scc1 L_interleave_layers__softmax_full_mha__moe_arch_mod__prompt_w2_68
    s_and_b32 s53, s6, 1
    s_cmp_eq_u32 s53, 0
    s_cselect_b32 s56, s68, s20
    s_cselect_b32 s57, s69, s21
    s_mov_b32 s58, 524288
    s_cselect_b32 s58, 1835008, s58
    s_cselect_b32 s60, 56, 16
    s_mov_b32 s59, 0x00020000
    s_sub_u32 s54, 384, s56
    s_and_b32 s54, s54, 0x380
    s_and_b32 s55, s2, 7
    s_lshl_b32 s55, s55, 7
    s_cmp_eq_u32 s55, s54
    s_cselect_b32 s55, 1, s53
    s_mul_i32 s58, s58, s55
    s_lshr_b32 s55, s2, 3
    s_mul_i32 s55, s55, s60
    s_lshl_b32 s55, s55, 10
    s_add_u32 s54, s54, s55
    v_lshlrev_b32 v2, 10, v1
    v_cmp_gt_u32 vcc, s60, v1
    s_nop 0
    s_mov_b64 exec, vcc
    buffer_load_dword v11, v2, s[56:59], s54 offen
    s_mov_b64 exec, -1
L_interleave_layers__softmax_full_mha__moe_arch_mod__prompt_w2_68:
L_interleave_layers__softmax_full_mha__moe_arch_mod__prompt_pf_69:
    v_exp_f32 v28, v28
    v_exp_f32 v29, v29
    v_exp_f32 v30, v30
    v_exp_f32 v31, v31
    v_exp_f32 v32, v32
    v_exp_f32 v33, v33
    v_smfmac_f32_32x32x32_bf16 v[48:63], v[88:91], v[24:31], v5
    v_exp_f32 v34, v34
    v_exp_f32 v35, v35
    v_exp_f32 v36, v36
    v_exp_f32 v37, v37
    v_exp_f32 v38, v38
    s_waitcnt lgkmcnt(0)
    v_mfma_f32_32x32x16_bf16 v[16:31], v[80:83], v[100:103], 0
    v_exp_f32 v39, v39
    v_exp_f32 v40, v40
    v_exp_f32 v41, v41
    v_exp_f32 v42, v42
    v_exp_f32 v43, v43
    v_smfmac_f32_32x32x32_bf16 v[64:79], v[84:87], v[32:39], v5
    v_exp_f32 v44, v44
    v_exp_f32 v45, v45
    v_exp_f32 v46, v46
    v_exp_f32 v47, v47
    s_nop 1
    v_exp_f32 v16, v16
    v_exp_f32 v17, v17
    v_smfmac_f32_32x32x32_bf16 v[64:79], v[88:91], v[40:47], v5
    s_mov_b64 exec, s[32:33]
    ds_read_b128 v[84:87], v7 offset:17408
    ds_read_b128 v[88:91], v7 offset:17664
    s_mov_b64 exec, -1
    v_exp_f32 v18, v18
    v_exp_f32 v19, v19
    v_exp_f32 v20, v20
    v_exp_f32 v21, v21
    v_exp_f32 v22, v22
    v_mfma_f32_32x32x16_bf16 v[32:47], v[80:83], v[104:107], 0
    ds_read_b128 v[80:83], v7 offset:16384
    v_exp_f32 v23, v23
    v_exp_f32 v24, v24
    v_exp_f32 v25, v25
    v_exp_f32 v26, v26
    v_exp_f32 v27, v27
    s_waitcnt lgkmcnt(3)
    v_smfmac_f32_32x32x32_bf16 v[48:63], v[92:95], v[16:23], v5
    v_exp_f32 v28, v28
    v_exp_f32 v29, v29
    v_exp_f32 v30, v30
    v_exp_f32 v31, v31
    v_exp_f32 v32, v32
    v_exp_f32 v33, v33
    v_smfmac_f32_32x32x32_bf16 v[48:63], v[96:99], v[24:31], v5
    v_exp_f32 v34, v34
    v_exp_f32 v35, v35
    v_exp_f32 v36, v36
    v_exp_f32 v37, v37
    v_exp_f32 v38, v38
    s_waitcnt lgkmcnt(0)
    v_mfma_f32_32x32x16_bf16 v[16:31], v[80:83], v[100:103], 0
    v_exp_f32 v39, v39
    v_exp_f32 v40, v40
    v_exp_f32 v41, v41
    v_exp_f32 v42, v42
    v_exp_f32 v43, v43
    v_smfmac_f32_32x32x32_bf16 v[64:79], v[92:95], v[32:39], v5
    v_exp_f32 v44, v44
    v_exp_f32 v45, v45
    v_exp_f32 v46, v46
    v_exp_f32 v47, v47
    s_nop 1
    v_exp_f32 v16, v16
    v_exp_f32 v17, v17
    v_smfmac_f32_32x32x32_bf16 v[64:79], v[96:99], v[40:47], v5
    s_mov_b64 exec, s[32:33]
    ds_read_b128 v[92:95], v7 offset:19456
    ds_read_b128 v[96:99], v7 offset:19712
    s_mov_b64 exec, -1
    v_exp_f32 v18, v18
    v_exp_f32 v19, v19
    v_exp_f32 v20, v20
    v_exp_f32 v21, v21
    v_exp_f32 v22, v22
    v_mfma_f32_32x32x16_bf16 v[32:47], v[80:83], v[104:107], 0
    ds_read_b128 v[80:83], v7 offset:18432
    v_exp_f32 v23, v23
    v_exp_f32 v24, v24
    v_exp_f32 v25, v25
    v_exp_f32 v26, v26
    v_exp_f32 v27, v27
    s_waitcnt lgkmcnt(3)
    v_smfmac_f32_32x32x32_bf16 v[48:63], v[84:87], v[16:23], v5
    v_exp_f32 v28, v28
    v_exp_f32 v29, v29
    v_exp_f32 v30, v30
    v_exp_f32 v31, v31
    v_exp_f32 v32, v32
    v_exp_f32 v33, v33
    v_smfmac_f32_32x32x32_bf16 v[48:63], v[88:91], v[24:31], v5
    v_exp_f32 v34, v34
    v_exp_f32 v35, v35
    v_exp_f32 v36, v36
    v_exp_f32 v37, v37
    v_exp_f32 v38, v38
    s_waitcnt lgkmcnt(0)
    v_mfma_f32_32x32x16_bf16 v[16:31], v[80:83], v[100:103], 0
    v_exp_f32 v39, v39
    v_exp_f32 v40, v40
    v_exp_f32 v41, v41
    v_exp_f32 v42, v42
    v_exp_f32 v43, v43
    v_smfmac_f32_32x32x32_bf16 v[64:79], v[84:87], v[32:39], v5
    v_exp_f32 v44, v44
    v_exp_f32 v45, v45
    v_exp_f32 v46, v46
    v_exp_f32 v47, v47
    s_nop 1
    v_exp_f32 v16, v16
    v_exp_f32 v17, v17
    v_smfmac_f32_32x32x32_bf16 v[64:79], v[88:91], v[40:47], v5
    s_mov_b64 exec, s[32:33]
    ds_read_b128 v[84:87], v7 offset:21504
    ds_read_b128 v[88:91], v7 offset:21760
    s_mov_b64 exec, -1
    v_exp_f32 v18, v18
    v_exp_f32 v19, v19
    v_exp_f32 v20, v20
    v_exp_f32 v21, v21
    v_exp_f32 v22, v22
    v_mfma_f32_32x32x16_bf16 v[32:47], v[80:83], v[104:107], 0
    ds_read_b128 v[80:83], v7 offset:20480
    v_exp_f32 v23, v23
    v_exp_f32 v24, v24
    v_exp_f32 v25, v25
    v_exp_f32 v26, v26
    v_exp_f32 v27, v27
    s_waitcnt lgkmcnt(3)
    v_smfmac_f32_32x32x32_bf16 v[48:63], v[92:95], v[16:23], v5
    s_cmp_lg_u32 s7, 0
    s_cbranch_scc1 L_interleave_layers__softmax_full_mha__moe_arch_mod__prompt_pf_60
    v_lshrrev_b32 v2, 1, v1
    v_mul_lo_u32 v2, v2, s101
    v_and_b32 v3, 1, v1
    v_lshl_add_u32 v10, v3, 4, v2
L_interleave_layers__softmax_full_mha__moe_arch_mod__prompt_pf_60:
    v_exp_f32 v28, v28
    v_exp_f32 v29, v29
    v_exp_f32 v30, v30
    v_exp_f32 v31, v31
    v_exp_f32 v32, v32
    v_exp_f32 v33, v33
    v_smfmac_f32_32x32x32_bf16 v[48:63], v[96:99], v[24:31], v5
    v_exp_f32 v34, v34
    v_exp_f32 v35, v35
    v_exp_f32 v36, v36
    v_exp_f32 v37, v37
    v_exp_f32 v38, v38
    s_waitcnt lgkmcnt(0)
    v_mfma_f32_32x32x16_bf16 v[16:31], v[80:83], v[100:103], 0
    v_exp_f32 v39, v39
    v_exp_f32 v40, v40
    v_exp_f32 v41, v41
    v_exp_f32 v42, v42
    v_exp_f32 v43, v43
    v_smfmac_f32_32x32x32_bf16 v[64:79], v[92:95], v[32:39], v5
    v_exp_f32 v44, v44
    v_exp_f32 v45, v45
    v_exp_f32 v46, v46
    v_exp_f32 v47, v47
    s_cmp_lg_u32 s88, 3
    s_cbranch_scc1 L_interleave_layers__softmax_full_mha__moe_arch_mod__prompt_ro_83
    s_call_b64 s[92:93], L_s3a
L_interleave_layers__softmax_full_mha__moe_arch_mod__prompt_ro_83:
    v_exp_f32 v16, v16
    v_exp_f32 v17, v17
    v_smfmac_f32_32x32x32_bf16 v[64:79], v[96:99], v[40:47], v5
    s_mov_b64 exec, s[32:33]
    ds_read_b128 v[92:95], v7 offset:23552
    ds_read_b128 v[96:99], v7 offset:23808
    s_mov_b64 exec, -1
    v_exp_f32 v18, v18
    v_exp_f32 v19, v19
    v_exp_f32 v20, v20
    v_exp_f32 v21, v21
    v_exp_f32 v22, v22
    v_mfma_f32_32x32x16_bf16 v[32:47], v[80:83], v[104:107], 0
    ds_read_b128 v[80:83], v7 offset:22528
    v_exp_f32 v23, v23
    v_exp_f32 v24, v24
    v_exp_f32 v25, v25
    v_exp_f32 v26, v26
    v_exp_f32 v27, v27
    s_waitcnt lgkmcnt(3)
    v_smfmac_f32_32x32x32_bf16 v[48:63], v[84:87], v[16:23], v5
    s_cmp_lg_u32 s7, 0
    s_cbranch_scc1 L_interleave_layers__softmax_full_mha__moe_arch_mod__prompt_pf_61
    buffer_load_dwordx4 v[192:195], v10, s[76:79], s94 offen
L_interleave_layers__softmax_full_mha__moe_arch_mod__prompt_pf_61:
    v_exp_f32 v28, v28
    v_exp_f32 v29, v29
    v_exp_f32 v30, v30
    v_exp_f32 v31, v31
    v_exp_f32 v32, v32
    v_exp_f32 v33, v33
    v_smfmac_f32_32x32x32_bf16 v[48:63], v[88:91], v[24:31], v5
    v_exp_f32 v34, v34
    v_exp_f32 v35, v35
    v_exp_f32 v36, v36
    v_exp_f32 v37, v37
    v_exp_f32 v38, v38
    s_waitcnt lgkmcnt(0)
    v_mfma_f32_32x32x16_bf16 v[16:31], v[80:83], v[100:103], 0
    v_exp_f32 v39, v39
    v_exp_f32 v40, v40
    v_exp_f32 v41, v41
    v_exp_f32 v42, v42
    v_exp_f32 v43, v43
    v_smfmac_f32_32x32x32_bf16 v[64:79], v[84:87], v[32:39], v5
    v_exp_f32 v44, v44
    v_exp_f32 v45, v45
    v_exp_f32 v46, v46
    v_exp_f32 v47, v47
    s_nop 1
    v_exp_f32 v16, v16
    v_exp_f32 v17, v17
    v_smfmac_f32_32x32x32_bf16 v[64:79], v[88:91], v[40:47], v5
    s_mov_b64 exec, s[32:33]
    ds_read_b128 v[84:87], v7 offset:25600
    ds_read_b128 v[88:91], v7 offset:25856
    s_mov_b64 exec, -1
    v_exp_f32 v18, v18
    v_exp_f32 v19, v19
    v_exp_f32 v20, v20
    v_exp_f32 v21, v21
    v_exp_f32 v22, v22
    v_mfma_f32_32x32x16_bf16 v[32:47], v[80:83], v[104:107], 0
    ds_read_b128 v[80:83], v7 offset:24576
    v_exp_f32 v23, v23
    v_exp_f32 v24, v24
    v_exp_f32 v25, v25
    v_exp_f32 v26, v26
    v_exp_f32 v27, v27
    s_waitcnt lgkmcnt(3)
    v_smfmac_f32_32x32x32_bf16 v[48:63], v[92:95], v[16:23], v5
    s_cmp_lg_u32 s7, 0
    s_cbranch_scc1 L_interleave_layers__softmax_full_mha__moe_arch_mod__prompt_pf_62
    buffer_load_dwordx4 v[196:199], v10, s[80:83], s95 offen
L_interleave_layers__softmax_full_mha__moe_arch_mod__prompt_pf_62:
    v_exp_f32 v28, v28
    v_exp_f32 v29, v29
    v_exp_f32 v30, v30
    v_exp_f32 v31, v31
    v_exp_f32 v32, v32
    v_exp_f32 v33, v33
    v_smfmac_f32_32x32x32_bf16 v[48:63], v[96:99], v[24:31], v5
    v_exp_f32 v34, v34
    v_exp_f32 v35, v35
    v_exp_f32 v36, v36
    v_exp_f32 v37, v37
    v_exp_f32 v38, v38
    s_waitcnt lgkmcnt(0)
    v_mfma_f32_32x32x16_bf16 v[16:31], v[80:83], v[100:103], 0
    v_exp_f32 v39, v39
    v_exp_f32 v40, v40
    v_exp_f32 v41, v41
    v_exp_f32 v42, v42
    v_exp_f32 v43, v43
    v_smfmac_f32_32x32x32_bf16 v[64:79], v[92:95], v[32:39], v5
    v_exp_f32 v44, v44
    v_exp_f32 v45, v45
    v_exp_f32 v46, v46
    v_exp_f32 v47, v47
    s_cmp_lg_u32 s88, 3
    s_cbranch_scc1 L_interleave_layers__softmax_full_mha__moe_arch_mod__prompt_ro_84
    s_waitcnt vmcnt(0)
    s_call_b64 s[92:93], L_s3b
L_interleave_layers__softmax_full_mha__moe_arch_mod__prompt_ro_84:
    v_exp_f32 v16, v16
    v_exp_f32 v17, v17
    v_smfmac_f32_32x32x32_bf16 v[64:79], v[96:99], v[40:47], v5
    s_mov_b64 exec, s[32:33]
    ds_read_b128 v[92:95], v7 offset:27648
    ds_read_b128 v[96:99], v7 offset:27904
    s_mov_b64 exec, -1
    v_exp_f32 v18, v18
    v_exp_f32 v19, v19
    v_exp_f32 v20, v20
    v_exp_f32 v21, v21
    v_exp_f32 v22, v22
    v_mfma_f32_32x32x16_bf16 v[32:47], v[80:83], v[104:107], 0
    ds_read_b128 v[80:83], v7 offset:26624
    v_exp_f32 v23, v23
    v_exp_f32 v24, v24
    v_exp_f32 v25, v25
    v_exp_f32 v26, v26
    v_exp_f32 v27, v27
    s_waitcnt lgkmcnt(3)
    v_smfmac_f32_32x32x32_bf16 v[48:63], v[84:87], v[16:23], v5
    s_cmp_lg_u32 s7, 0
    s_cbranch_scc1 L_interleave_layers__softmax_full_mha__moe_arch_mod__prompt_pf_63
    buffer_load_dwordx4 v[200:203], v10, s[76:79], s96 offen
L_interleave_layers__softmax_full_mha__moe_arch_mod__prompt_pf_63:
    v_exp_f32 v28, v28
    v_exp_f32 v29, v29
    v_exp_f32 v30, v30
    v_exp_f32 v31, v31
    v_exp_f32 v32, v32
    v_exp_f32 v33, v33
    v_smfmac_f32_32x32x32_bf16 v[48:63], v[88:91], v[24:31], v5
    v_exp_f32 v34, v34
    v_exp_f32 v35, v35
    v_exp_f32 v36, v36
    v_exp_f32 v37, v37
    v_exp_f32 v38, v38
    s_waitcnt lgkmcnt(0)
    v_mfma_f32_32x32x16_bf16 v[16:31], v[80:83], v[100:103], 0
    v_exp_f32 v39, v39
    v_exp_f32 v40, v40
    v_exp_f32 v41, v41
    v_exp_f32 v42, v42
    v_exp_f32 v43, v43
    v_smfmac_f32_32x32x32_bf16 v[64:79], v[84:87], v[32:39], v5
    v_exp_f32 v44, v44
    v_exp_f32 v45, v45
    v_exp_f32 v46, v46
    v_exp_f32 v47, v47
    s_nop 1
    v_exp_f32 v16, v16
    v_exp_f32 v17, v17
    v_smfmac_f32_32x32x32_bf16 v[64:79], v[88:91], v[40:47], v5
    s_mov_b64 exec, s[32:33]
    ds_read_b128 v[84:87], v7 offset:29696
    ds_read_b128 v[88:91], v7 offset:29952
    s_mov_b64 exec, -1
    v_exp_f32 v18, v18
    v_exp_f32 v19, v19
    v_exp_f32 v20, v20
    v_exp_f32 v21, v21
    v_exp_f32 v22, v22
    v_mfma_f32_32x32x16_bf16 v[32:47], v[80:83], v[104:107], 0
    ds_read_b128 v[80:83], v7 offset:28672
    v_exp_f32 v23, v23
    v_exp_f32 v24, v24
    v_exp_f32 v25, v25
    v_exp_f32 v26, v26
    v_exp_f32 v27, v27
    s_waitcnt lgkmcnt(3)
    v_smfmac_f32_32x32x32_bf16 v[48:63], v[92:95], v[16:23], v5
    s_cmp_lg_u32 s7, 0
    s_cbranch_scc1 L_interleave_layers__softmax_full_mha__moe_arch_mod__prompt_pf_64
    buffer_load_dwordx4 v[204:207], v10, s[80:83], s97 offen
L_interleave_layers__softmax_full_mha__moe_arch_mod__prompt_pf_64:
    v_exp_f32 v28, v28
    v_exp_f32 v29, v29
    v_exp_f32 v30, v30
    v_exp_f32 v31, v31
    v_exp_f32 v32, v32
    v_exp_f32 v33, v33
    v_smfmac_f32_32x32x32_bf16 v[48:63], v[96:99], v[24:31], v5
    v_exp_f32 v34, v34
    v_exp_f32 v35, v35
    v_exp_f32 v36, v36
    v_exp_f32 v37, v37
    v_exp_f32 v38, v38
    s_waitcnt lgkmcnt(0)
    v_mfma_f32_32x32x16_bf16 v[16:31], v[80:83], v[100:103], 0
    v_exp_f32 v39, v39
    v_exp_f32 v40, v40
    v_exp_f32 v41, v41
    v_exp_f32 v42, v42
    v_exp_f32 v43, v43
    v_smfmac_f32_32x32x32_bf16 v[64:79], v[92:95], v[32:39], v5
    v_exp_f32 v44, v44
    v_exp_f32 v45, v45
    v_exp_f32 v46, v46
    v_exp_f32 v47, v47
    s_nop 1
    v_exp_f32 v16, v16
    v_exp_f32 v17, v17
    v_smfmac_f32_32x32x32_bf16 v[64:79], v[96:99], v[40:47], v5
    s_mov_b64 exec, s[32:33]
    ds_read_b128 v[92:95], v7 offset:31744
    ds_read_b128 v[96:99], v7 offset:32000
    s_mov_b64 exec, -1
    v_exp_f32 v18, v18
    v_exp_f32 v19, v19
    v_exp_f32 v20, v20
    v_exp_f32 v21, v21
    v_exp_f32 v22, v22
    v_mfma_f32_32x32x16_bf16 v[32:47], v[80:83], v[104:107], 0
    ds_read_b128 v[80:83], v7 offset:30720
    v_exp_f32 v23, v23
    v_exp_f32 v24, v24
    v_exp_f32 v25, v25
    v_exp_f32 v26, v26
    v_exp_f32 v27, v27
    s_waitcnt lgkmcnt(3)
    v_smfmac_f32_32x32x32_bf16 v[48:63], v[84:87], v[16:23], v5
    s_cmp_lg_u32 s7, 0
    s_cbranch_scc1 L_interleave_layers__softmax_full_mha__moe_arch_mod__prompt_pf_65
    buffer_load_dwordx4 v[208:211], v10, s[76:79], s98 offen
L_interleave_layers__softmax_full_mha__moe_arch_mod__prompt_pf_65:
    v_exp_f32 v28, v28
    v_exp_f32 v29, v29
    v_exp_f32 v30, v30
    v_exp_f32 v31, v31
    v_exp_f32 v32, v32
    v_exp_f32 v33, v33
    v_smfmac_f32_32x32x32_bf16 v[48:63], v[88:91], v[24:31], v5
    v_exp_f32 v34, v34
    v_exp_f32 v35, v35
    v_exp_f32 v36, v36
    v_exp_f32 v37, v37
    v_exp_f32 v38, v38
    s_waitcnt lgkmcnt(0)
    v_mfma_f32_32x32x16_bf16 v[16:31], v[80:83], v[100:103], 0
    v_exp_f32 v39, v39
    v_exp_f32 v40, v40
    v_exp_f32 v41, v41
    v_exp_f32 v42, v42
    v_exp_f32 v43, v43
    v_smfmac_f32_32x32x32_bf16 v[64:79], v[84:87], v[32:39], v5
    v_exp_f32 v44, v44
    v_exp_f32 v45, v45
    v_exp_f32 v46, v46
    v_exp_f32 v47, v47
    s_nop 1
    v_exp_f32 v16, v16
    v_exp_f32 v17, v17
    v_smfmac_f32_32x32x32_bf16 v[64:79], v[88:91], v[40:47], v5
    s_mov_b64 exec, s[32:33]
    ds_read_b128 v[84:87], v7 offset:33792
    ds_read_b128 v[88:91], v7 offset:34048
    s_mov_b64 exec, -1
    v_exp_f32 v18, v18
    v_exp_f32 v19, v19
    v_exp_f32 v20, v20
    v_exp_f32 v21, v21
    v_exp_f32 v22, v22
    v_mfma_f32_32x32x16_bf16 v[32:47], v[80:83], v[104:107], 0
    ds_read_b128 v[80:83], v7 offset:32768
    v_exp_f32 v23, v23
    v_exp_f32 v24, v24
    v_exp_f32 v25, v25
    v_exp_f32 v26, v26
    v_exp_f32 v27, v27
    s_waitcnt lgkmcnt(3)
    v_smfmac_f32_32x32x32_bf16 v[48:63], v[92:95], v[16:23], v5
    s_cmp_lg_u32 s7, 0
    s_cbranch_scc1 L_interleave_layers__softmax_full_mha__moe_arch_mod__prompt_pf_66
    buffer_load_dwordx4 v[212:215], v10, s[80:83], s99 offen
L_interleave_layers__softmax_full_mha__moe_arch_mod__prompt_pf_66:
    v_exp_f32 v28, v28
    v_exp_f32 v29, v29
    v_exp_f32 v30, v30
    v_exp_f32 v31, v31
    v_exp_f32 v32, v32
    v_exp_f32 v33, v33
    v_smfmac_f32_32x32x32_bf16 v[48:63], v[96:99], v[24:31], v5
    v_exp_f32 v34, v34
    v_exp_f32 v35, v35
    v_exp_f32 v36, v36
    v_exp_f32 v37, v37
    v_exp_f32 v38, v38
    s_waitcnt lgkmcnt(0)
    v_mfma_f32_32x32x16_bf16 v[16:31], v[80:83], v[100:103], 0
    v_exp_f32 v39, v39
    v_exp_f32 v40, v40
    v_exp_f32 v41, v41
    v_exp_f32 v42, v42
    v_exp_f32 v43, v43
    v_smfmac_f32_32x32x32_bf16 v[64:79], v[92:95], v[32:39], v5
    v_exp_f32 v44, v44
    v_exp_f32 v45, v45
    v_exp_f32 v46, v46
    v_exp_f32 v47, v47
    s_nop 1
    v_exp_f32 v16, v16
    v_exp_f32 v17, v17
    v_smfmac_f32_32x32x32_bf16 v[64:79], v[96:99], v[40:47], v5
    s_mov_b64 exec, s[32:33]
    ds_read_b128 v[92:95], v7 offset:35840
    ds_read_b128 v[96:99], v7 offset:36096
    s_mov_b64 exec, -1
    v_exp_f32 v18, v18
    v_exp_f32 v19, v19
    v_exp_f32 v20, v20
    v_exp_f32 v21, v21
    v_exp_f32 v22, v22
    v_mfma_f32_32x32x16_bf16 v[32:47], v[80:83], v[104:107], 0
    ds_read_b128 v[80:83], v7 offset:34816
    v_exp_f32 v23, v23
    v_exp_f32 v24, v24
    v_exp_f32 v25, v25
    v_exp_f32 v26, v26
    v_exp_f32 v27, v27
    s_waitcnt lgkmcnt(3)
    v_smfmac_f32_32x32x32_bf16 v[48:63], v[84:87], v[16:23], v5
    s_cmp_lg_u32 s7, 0
    s_cbranch_scc1 L_interleave_layers__softmax_full_mha__moe_arch_mod__prompt_pf_67
    buffer_load_dwordx4 v[216:219], v10, s[76:79], s100 offen
L_interleave_layers__softmax_full_mha__moe_arch_mod__prompt_pf_67:
    v_exp_f32 v28, v28
    v_exp_f32 v29, v29
    v_exp_f32 v30, v30
    v_exp_f32 v31, v31
    v_exp_f32 v32, v32
    v_exp_f32 v33, v33
    v_smfmac_f32_32x32x32_bf16 v[48:63], v[88:91], v[24:31], v5
    v_exp_f32 v34, v34
    v_exp_f32 v35, v35
    v_exp_f32 v36, v36
    v_exp_f32 v37, v37
    v_exp_f32 v38, v38
    s_waitcnt lgkmcnt(0)
    v_mfma_f32_32x32x16_bf16 v[16:31], v[80:83], v[100:103], 0
    v_exp_f32 v39, v39
    v_exp_f32 v40, v40
    v_exp_f32 v41, v41
    v_exp_f32 v42, v42
    v_exp_f32 v43, v43
    v_smfmac_f32_32x32x32_bf16 v[64:79], v[84:87], v[32:39], v5
    v_exp_f32 v44, v44
    v_exp_f32 v45, v45
    v_exp_f32 v46, v46
    v_exp_f32 v47, v47
    s_nop 1
    v_exp_f32 v16, v16
    v_exp_f32 v17, v17
    v_smfmac_f32_32x32x32_bf16 v[64:79], v[88:91], v[40:47], v5
    s_mov_b64 exec, s[32:33]
    ds_read_b128 v[84:87], v7 offset:37888
    ds_read_b128 v[88:91], v7 offset:38144
    s_mov_b64 exec, -1
    v_exp_f32 v18, v18
    v_exp_f32 v19, v19
    v_exp_f32 v20, v20
    v_exp_f32 v21, v21
    v_exp_f32 v22, v22
    v_mfma_f32_32x32x16_bf16 v[32:47], v[80:83], v[104:107], 0
    ds_read_b128 v[80:83], v7 offset:36864
    v_exp_f32 v23, v23
    v_exp_f32 v24, v24
    v_exp_f32 v25, v25
    v_exp_f32 v26, v26
    v_exp_f32 v27, v27
    s_waitcnt lgkmcnt(3)
    v_smfmac_f32_32x32x32_bf16 v[48:63], v[92:95], v[16:23], v5
    v_exp_f32 v28, v28
    v_exp_f32 v29, v29
    v_exp_f32 v30, v30
    v_exp_f32 v31, v31
    v_exp_f32 v32, v32
    v_exp_f32 v33, v33
    v_smfmac_f32_32x32x32_bf16 v[48:63], v[96:99], v[24:31], v5
    v_exp_f32 v34, v34
    v_exp_f32 v35, v35
    v_exp_f32 v36, v36
    v_exp_f32 v37, v37
    v_exp_f32 v38, v38
    s_waitcnt lgkmcnt(0)
    v_mfma_f32_32x32x16_bf16 v[16:31], v[80:83], v[100:103], 0
    v_exp_f32 v39, v39
    v_exp_f32 v40, v40
    v_exp_f32 v41, v41
    v_exp_f32 v42, v42
    v_exp_f32 v43, v43
    v_smfmac_f32_32x32x32_bf16 v[64:79], v[92:95], v[32:39], v5
    s_cmp_lg_u32 s7, 0
    s_cbranch_scc1 L_interleave_layers__softmax_full_mha__moe_arch_mod__prompt_pf_70
    v_lshrrev_b32 v2, 3, v1
    v_lshlrev_b32 v2, 10, v2
    v_and_b32 v3, 7, v1
    v_lshl_add_u32 v8, v3, 4, v2
    s_and_b32 s39, s4, 7
    s_lshl_b32 s39, s39, 7
    s_lshl_b32 s53, s6, 13
    s_add_u32 s39, s39, s53
    buffer_load_dwordx4 v[224:227], v8, s[20:23], s39 offen
L_interleave_layers__softmax_full_mha__moe_arch_mod__prompt_pf_70:
    v_exp_f32 v44, v44
    v_exp_f32 v45, v45
    v_exp_f32 v46, v46
    v_exp_f32 v47, v47
    v_exp_f32 v16, v16
    v_exp_f32 v17, v17
    v_smfmac_f32_32x32x32_bf16 v[64:79], v[96:99], v[40:47], v5
    s_mov_b64 exec, s[32:33]
    ds_read_b128 v[92:95], v7 offset:39936
    ds_read_b128 v[96:99], v7 offset:40192
    s_mov_b64 exec, -1
    v_exp_f32 v18, v18
    v_exp_f32 v19, v19
    v_exp_f32 v20, v20
    v_exp_f32 v21, v21
    v_exp_f32 v22, v22
    v_mfma_f32_32x32x16_bf16 v[32:47], v[80:83], v[104:107], 0
    ds_read_b128 v[80:83], v7 offset:38912
    v_exp_f32 v23, v23
    v_exp_f32 v24, v24
    v_exp_f32 v25, v25
    v_exp_f32 v26, v26
    v_exp_f32 v27, v27
    s_waitcnt lgkmcnt(3)
    v_smfmac_f32_32x32x32_bf16 v[48:63], v[84:87], v[16:23], v5
    v_exp_f32 v28, v28
    v_exp_f32 v29, v29
    v_exp_f32 v30, v30
    v_exp_f32 v31, v31
    v_exp_f32 v32, v32
    v_exp_f32 v33, v33
    v_smfmac_f32_32x32x32_bf16 v[48:63], v[88:91], v[24:31], v5
    v_exp_f32 v34, v34
    v_exp_f32 v35, v35
    v_exp_f32 v36, v36
    v_exp_f32 v37, v37
    v_exp_f32 v38, v38
    s_waitcnt lgkmcnt(0)
    v_mfma_f32_32x32x16_bf16 v[16:31], v[80:83], v[100:103], 0
    v_exp_f32 v39, v39
    v_exp_f32 v40, v40
    v_exp_f32 v41, v41
    v_exp_f32 v42, v42
    v_exp_f32 v43, v43
    v_smfmac_f32_32x32x32_bf16 v[64:79], v[84:87], v[32:39], v5
    s_cmp_lg_u32 s7, 0
    s_cbranch_scc1 L_interleave_layers__softmax_full_mha__moe_arch_mod__prompt_pf_71
    s_add_u32 s39, s39, 0x10000
    buffer_load_dwordx4 v[228:231], v8, s[20:23], s39 offen
L_interleave_layers__softmax_full_mha__moe_arch_mod__prompt_pf_71:
    v_exp_f32 v44, v44
    v_exp_f32 v45, v45
    v_exp_f32 v46, v46
    v_exp_f32 v47, v47
    v_exp_f32 v16, v16
    v_exp_f32 v17, v17
    v_smfmac_f32_32x32x32_bf16 v[64:79], v[88:91], v[40:47], v5
    s_mov_b64 exec, s[32:33]
    ds_read_b128 v[84:87], v7 offset:41984
    ds_read_b128 v[88:91], v7 offset:42240
    s_mov_b64 exec, -1
    v_exp_f32 v18, v18
    v_exp_f32 v19, v19
    v_exp_f32 v20, v20
    v_exp_f32 v21, v21
    v_exp_f32 v22, v22
    v_mfma_f32_32x32x16_bf16 v[32:47], v[80:83], v[104:107], 0
    ds_read_b128 v[80:83], v7 offset:40960
    v_exp_f32 v23, v23
    v_exp_f32 v24, v24
    v_exp_f32 v25, v25
    v_exp_f32 v26, v26
    v_exp_f32 v27, v27
    s_waitcnt lgkmcnt(3)
    v_smfmac_f32_32x32x32_bf16 v[48:63], v[92:95], v[16:23], v5
    v_exp_f32 v28, v28
    v_exp_f32 v29, v29
    v_exp_f32 v30, v30
    v_exp_f32 v31, v31
    v_exp_f32 v32, v32
    v_exp_f32 v33, v33
    v_smfmac_f32_32x32x32_bf16 v[48:63], v[96:99], v[24:31], v5
    v_exp_f32 v34, v34
    v_exp_f32 v35, v35
    v_exp_f32 v36, v36
    v_exp_f32 v37, v37
    v_exp_f32 v38, v38
    s_waitcnt lgkmcnt(0)
    v_mfma_f32_32x32x16_bf16 v[16:31], v[80:83], v[100:103], 0
    v_exp_f32 v39, v39
    v_exp_f32 v40, v40
    v_exp_f32 v41, v41
    v_exp_f32 v42, v42
    v_exp_f32 v43, v43
    v_smfmac_f32_32x32x32_bf16 v[64:79], v[92:95], v[32:39], v5
    s_cmp_lg_u32 s7, 0
    s_cbranch_scc1 L_interleave_layers__softmax_full_mha__moe_arch_mod__prompt_pf_72
    s_add_u32 s39, s39, 0x10000
    buffer_load_dwordx4 v[232:235], v8, s[20:23], s39 offen
L_interleave_layers__softmax_full_mha__moe_arch_mod__prompt_pf_72:
    v_exp_f32 v44, v44
    v_exp_f32 v45, v45
    v_exp_f32 v46, v46
    v_exp_f32 v47, v47
    v_exp_f32 v16, v16
    v_exp_f32 v17, v17
    v_smfmac_f32_32x32x32_bf16 v[64:79], v[96:99], v[40:47], v5
    s_mov_b64 exec, s[32:33]
    ds_read_b128 v[92:95], v7 offset:44032
    ds_read_b128 v[96:99], v7 offset:44288
    s_mov_b64 exec, -1
    v_exp_f32 v18, v18
    v_exp_f32 v19, v19
    v_exp_f32 v20, v20
    v_exp_f32 v21, v21
    v_exp_f32 v22, v22
    v_mfma_f32_32x32x16_bf16 v[32:47], v[80:83], v[104:107], 0
    ds_read_b128 v[80:83], v7 offset:43008
    v_exp_f32 v23, v23
    v_exp_f32 v24, v24
    v_exp_f32 v25, v25
    v_exp_f32 v26, v26
    v_exp_f32 v27, v27
    s_waitcnt lgkmcnt(3)
    v_smfmac_f32_32x32x32_bf16 v[48:63], v[84:87], v[16:23], v5
    v_exp_f32 v28, v28
    v_exp_f32 v29, v29
    v_exp_f32 v30, v30
    v_exp_f32 v31, v31
    v_exp_f32 v32, v32
    v_exp_f32 v33, v33
    v_smfmac_f32_32x32x32_bf16 v[48:63], v[88:91], v[24:31], v5
    v_exp_f32 v34, v34
    v_exp_f32 v35, v35
    v_exp_f32 v36, v36
    v_exp_f32 v37, v37
    v_exp_f32 v38, v38
    s_waitcnt lgkmcnt(0)
    v_mfma_f32_32x32x16_bf16 v[16:31], v[80:83], v[100:103], 0
    v_exp_f32 v39, v39
    v_exp_f32 v40, v40
    v_exp_f32 v41, v41
    v_exp_f32 v42, v42
    v_exp_f32 v43, v43
    v_smfmac_f32_32x32x32_bf16 v[64:79], v[84:87], v[32:39], v5
    s_cmp_lg_u32 s7, 0
    s_cbranch_scc1 L_interleave_layers__softmax_full_mha__moe_arch_mod__prompt_pf_73
    s_add_u32 s39, s39, 0x10000
    buffer_load_dwordx4 v[236:239], v8, s[20:23], s39 offen
L_interleave_layers__softmax_full_mha__moe_arch_mod__prompt_pf_73:
    v_exp_f32 v44, v44
    v_exp_f32 v45, v45
    v_exp_f32 v46, v46
    v_exp_f32 v47, v47
    v_exp_f32 v16, v16
    v_exp_f32 v17, v17
    v_smfmac_f32_32x32x32_bf16 v[64:79], v[88:91], v[40:47], v5
    s_mov_b64 exec, s[32:33]
    ds_read_b128 v[84:87], v7 offset:46080
    ds_read_b128 v[88:91], v7 offset:46336
    s_mov_b64 exec, -1
    v_exp_f32 v18, v18
    v_exp_f32 v19, v19
    v_exp_f32 v20, v20
    v_exp_f32 v21, v21
    v_exp_f32 v22, v22
    v_mfma_f32_32x32x16_bf16 v[32:47], v[80:83], v[104:107], 0
    ds_read_b128 v[80:83], v7 offset:45056
    v_exp_f32 v23, v23
    v_exp_f32 v24, v24
    v_exp_f32 v25, v25
    v_exp_f32 v26, v26
    v_exp_f32 v27, v27
    s_waitcnt lgkmcnt(3)
    v_smfmac_f32_32x32x32_bf16 v[48:63], v[92:95], v[16:23], v5
    v_exp_f32 v28, v28
    v_exp_f32 v29, v29
    v_exp_f32 v30, v30
    v_exp_f32 v31, v31
    v_exp_f32 v32, v32
    v_exp_f32 v33, v33
    v_smfmac_f32_32x32x32_bf16 v[48:63], v[96:99], v[24:31], v5
    v_exp_f32 v34, v34
    v_exp_f32 v35, v35
    v_exp_f32 v36, v36
    v_exp_f32 v37, v37
    v_exp_f32 v38, v38
    s_waitcnt lgkmcnt(0)
    v_mfma_f32_32x32x16_bf16 v[16:31], v[80:83], v[100:103], 0
    v_exp_f32 v39, v39
    v_exp_f32 v40, v40
    v_exp_f32 v41, v41
    v_exp_f32 v42, v42
    v_exp_f32 v43, v43
    v_smfmac_f32_32x32x32_bf16 v[64:79], v[92:95], v[32:39], v5
    s_cmp_lg_u32 s7, 0
    s_cbranch_scc1 L_interleave_layers__softmax_full_mha__moe_arch_mod__prompt_pf_74
    s_add_u32 s39, s39, 0x10000
    buffer_load_dwordx4 v[240:243], v8, s[20:23], s39 offen
L_interleave_layers__softmax_full_mha__moe_arch_mod__prompt_pf_74:
    v_exp_f32 v44, v44
    v_exp_f32 v45, v45
    v_exp_f32 v46, v46
    v_exp_f32 v47, v47
    v_exp_f32 v16, v16
    v_exp_f32 v17, v17
    v_smfmac_f32_32x32x32_bf16 v[64:79], v[96:99], v[40:47], v5
    s_mov_b64 exec, s[32:33]
    ds_read_b128 v[92:95], v7 offset:48128
    ds_read_b128 v[96:99], v7 offset:48384
    s_mov_b64 exec, -1
    v_exp_f32 v18, v18
    v_exp_f32 v19, v19
    v_exp_f32 v20, v20
    v_exp_f32 v21, v21
    v_exp_f32 v22, v22
    v_mfma_f32_32x32x16_bf16 v[32:47], v[80:83], v[104:107], 0
    ds_read_b128 v[80:83], v7 offset:47104
    v_exp_f32 v23, v23
    v_exp_f32 v24, v24
    v_exp_f32 v25, v25
    v_exp_f32 v26, v26
    v_exp_f32 v27, v27
    s_waitcnt lgkmcnt(3)
    v_smfmac_f32_32x32x32_bf16 v[48:63], v[84:87], v[16:23], v5
    v_exp_f32 v28, v28
    v_exp_f32 v29, v29
    v_exp_f32 v30, v30
    v_exp_f32 v31, v31
    v_exp_f32 v32, v32
    v_exp_f32 v33, v33
    v_smfmac_f32_32x32x32_bf16 v[48:63], v[88:91], v[24:31], v5
    v_exp_f32 v34, v34
    v_exp_f32 v35, v35
    v_exp_f32 v36, v36
    v_exp_f32 v37, v37
    v_exp_f32 v38, v38
    s_waitcnt lgkmcnt(0)
    v_mfma_f32_32x32x16_bf16 v[16:31], v[80:83], v[100:103], 0
    v_exp_f32 v39, v39
    v_exp_f32 v40, v40
    v_exp_f32 v41, v41
    v_exp_f32 v42, v42
    v_exp_f32 v43, v43
    v_smfmac_f32_32x32x32_bf16 v[64:79], v[84:87], v[32:39], v5
    s_cmp_lg_u32 s7, 0
    s_cbranch_scc1 L_interleave_layers__softmax_full_mha__moe_arch_mod__prompt_pf_75
    s_add_u32 s39, s39, 0x10000
    buffer_load_dwordx4 v[244:247], v8, s[20:23], s39 offen
L_interleave_layers__softmax_full_mha__moe_arch_mod__prompt_pf_75:
    v_exp_f32 v44, v44
    v_exp_f32 v45, v45
    v_exp_f32 v46, v46
    v_exp_f32 v47, v47
    v_exp_f32 v16, v16
    v_exp_f32 v17, v17
    v_smfmac_f32_32x32x32_bf16 v[64:79], v[88:91], v[40:47], v5
    s_mov_b64 exec, s[32:33]
    ds_read_b128 v[84:87], v7 offset:50176
    ds_read_b128 v[88:91], v7 offset:50432
    s_mov_b64 exec, -1
    v_exp_f32 v18, v18
    v_exp_f32 v19, v19
    v_exp_f32 v20, v20
    v_exp_f32 v21, v21
    v_exp_f32 v22, v22
    v_mfma_f32_32x32x16_bf16 v[32:47], v[80:83], v[104:107], 0
    ds_read_b128 v[80:83], v7 offset:49152
    v_exp_f32 v23, v23
    v_exp_f32 v24, v24
    v_exp_f32 v25, v25
    v_exp_f32 v26, v26
    v_exp_f32 v27, v27
    s_waitcnt lgkmcnt(3)
    v_smfmac_f32_32x32x32_bf16 v[48:63], v[92:95], v[16:23], v5
    v_exp_f32 v28, v28
    v_exp_f32 v29, v29
    v_exp_f32 v30, v30
    v_exp_f32 v31, v31
    v_exp_f32 v32, v32
    v_exp_f32 v33, v33
    v_smfmac_f32_32x32x32_bf16 v[48:63], v[96:99], v[24:31], v5
    v_exp_f32 v34, v34
    v_exp_f32 v35, v35
    v_exp_f32 v36, v36
    v_exp_f32 v37, v37
    v_exp_f32 v38, v38
    s_waitcnt lgkmcnt(0)
    v_mfma_f32_32x32x16_bf16 v[16:31], v[80:83], v[100:103], 0
    v_exp_f32 v39, v39
    v_exp_f32 v40, v40
    v_exp_f32 v41, v41
    v_exp_f32 v42, v42
    v_exp_f32 v43, v43
    v_smfmac_f32_32x32x32_bf16 v[64:79], v[92:95], v[32:39], v5
    s_cmp_lg_u32 s7, 0
    s_cbranch_scc1 L_interleave_layers__softmax_full_mha__moe_arch_mod__prompt_pf_76
    s_add_u32 s39, s39, 0x10000
    buffer_load_dwordx4 v[248:251], v8, s[20:23], s39 offen
L_interleave_layers__softmax_full_mha__moe_arch_mod__prompt_pf_76:
    v_exp_f32 v44, v44
    v_exp_f32 v45, v45
    v_exp_f32 v46, v46
    v_exp_f32 v47, v47
    v_exp_f32 v16, v16
    v_exp_f32 v17, v17
    v_smfmac_f32_32x32x32_bf16 v[64:79], v[96:99], v[40:47], v5
    s_mov_b64 exec, s[32:33]
    ds_read_b128 v[92:95], v7 offset:52224
    ds_read_b128 v[96:99], v7 offset:52480
    s_mov_b64 exec, -1
    v_exp_f32 v18, v18
    v_exp_f32 v19, v19
    v_exp_f32 v20, v20
    v_exp_f32 v21, v21
    v_exp_f32 v22, v22
    v_mfma_f32_32x32x16_bf16 v[32:47], v[80:83], v[104:107], 0
    ds_read_b128 v[80:83], v7 offset:51200
    v_exp_f32 v23, v23
    v_exp_f32 v24, v24
    v_exp_f32 v25, v25
    v_exp_f32 v26, v26
    v_exp_f32 v27, v27
    s_waitcnt lgkmcnt(3)
    v_smfmac_f32_32x32x32_bf16 v[48:63], v[84:87], v[16:23], v5
    v_exp_f32 v28, v28
    v_exp_f32 v29, v29
    v_exp_f32 v30, v30
    v_exp_f32 v31, v31
    v_exp_f32 v32, v32
    v_exp_f32 v33, v33
    v_smfmac_f32_32x32x32_bf16 v[48:63], v[88:91], v[24:31], v5
    v_exp_f32 v34, v34
    v_exp_f32 v35, v35
    v_exp_f32 v36, v36
    v_exp_f32 v37, v37
    v_exp_f32 v38, v38
    s_waitcnt lgkmcnt(0)
    v_mfma_f32_32x32x16_bf16 v[16:31], v[80:83], v[100:103], 0
    v_exp_f32 v39, v39
    v_exp_f32 v40, v40
    v_exp_f32 v41, v41
    v_exp_f32 v42, v42
    v_exp_f32 v43, v43
    v_smfmac_f32_32x32x32_bf16 v[64:79], v[84:87], v[32:39], v5
    s_cmp_lg_u32 s7, 0
    s_cbranch_scc1 L_interleave_layers__softmax_full_mha__moe_arch_mod__prompt_pf_77
    s_add_u32 s39, s39, 0x10000
    buffer_load_dwordx4 v[252:255], v8, s[20:23], s39 offen
L_interleave_layers__softmax_full_mha__moe_arch_mod__prompt_pf_77:
    v_exp_f32 v44, v44
    v_exp_f32 v45, v45
    v_exp_f32 v46, v46
    v_exp_f32 v47, v47
    v_exp_f32 v16, v16
    v_exp_f32 v17, v17
    v_smfmac_f32_32x32x32_bf16 v[64:79], v[88:91], v[40:47], v5
    s_mov_b64 exec, s[32:33]
    ds_read_b128 v[84:87], v7 offset:54272
    ds_read_b128 v[88:91], v7 offset:54528
    s_mov_b64 exec, -1
    v_exp_f32 v18, v18
    v_exp_f32 v19, v19
    v_exp_f32 v20, v20
    v_exp_f32 v21, v21
    v_exp_f32 v22, v22
    v_mfma_f32_32x32x16_bf16 v[32:47], v[80:83], v[104:107], 0
    ds_read_b128 v[80:83], v7 offset:53248
    v_exp_f32 v23, v23
    v_exp_f32 v24, v24
    v_exp_f32 v25, v25
    v_exp_f32 v26, v26
    v_exp_f32 v27, v27
    s_waitcnt lgkmcnt(3)
    v_smfmac_f32_32x32x32_bf16 v[48:63], v[92:95], v[16:23], v5
    v_exp_f32 v28, v28
    v_exp_f32 v29, v29
    v_exp_f32 v30, v30
    v_exp_f32 v31, v31
    v_exp_f32 v32, v32
    v_exp_f32 v33, v33
    v_smfmac_f32_32x32x32_bf16 v[48:63], v[96:99], v[24:31], v5
    v_exp_f32 v34, v34
    v_exp_f32 v35, v35
    v_exp_f32 v36, v36
    v_exp_f32 v37, v37
    v_exp_f32 v38, v38
    s_waitcnt lgkmcnt(0)
    v_mfma_f32_32x32x16_bf16 v[16:31], v[80:83], v[100:103], 0
    v_exp_f32 v39, v39
    v_exp_f32 v40, v40
    v_exp_f32 v41, v41
    v_exp_f32 v42, v42
    v_exp_f32 v43, v43
    v_smfmac_f32_32x32x32_bf16 v[64:79], v[92:95], v[32:39], v5
    v_exp_f32 v44, v44
    v_exp_f32 v45, v45
    v_exp_f32 v46, v46
    v_exp_f32 v47, v47
    s_and_b32 s52, s7, s41
    s_cmp_eq_u32 s52, 0
    s_cbranch_scc1 L_interleave_layers__softmax_full_mha__moe_arch_mod__prompt_lt_85
    s_call_b64 s[92:93], L_patcha
L_interleave_layers__softmax_full_mha__moe_arch_mod__prompt_lt_85:
    v_exp_f32 v16, v16
    v_exp_f32 v17, v17
    v_smfmac_f32_32x32x32_bf16 v[64:79], v[96:99], v[40:47], v5
    s_mov_b64 exec, s[32:33]
    ds_read_b128 v[92:95], v7 offset:56320
    ds_read_b128 v[96:99], v7 offset:56576
    s_mov_b64 exec, -1
    v_exp_f32 v18, v18
    v_exp_f32 v19, v19
    v_exp_f32 v20, v20
    v_exp_f32 v21, v21
    v_exp_f32 v22, v22
    v_mfma_f32_32x32x16_bf16 v[32:47], v[80:83], v[104:107], 0
    ds_read_b128 v[80:83], v7 offset:55296
    v_exp_f32 v23, v23
    v_exp_f32 v24, v24
    v_exp_f32 v25, v25
    v_exp_f32 v26, v26
    v_exp_f32 v27, v27
    s_waitcnt lgkmcnt(3)
    v_smfmac_f32_32x32x32_bf16 v[48:63], v[84:87], v[16:23], v5
    v_exp_f32 v28, v28
    v_exp_f32 v29, v29
    v_exp_f32 v30, v30
    v_exp_f32 v31, v31
    v_exp_f32 v32, v32
    v_exp_f32 v33, v33
    v_smfmac_f32_32x32x32_bf16 v[48:63], v[88:91], v[24:31], v5
    v_exp_f32 v34, v34
    v_exp_f32 v35, v35
    v_exp_f32 v36, v36
    v_exp_f32 v37, v37
    v_exp_f32 v38, v38
    s_waitcnt lgkmcnt(0)
    v_mfma_f32_32x32x16_bf16 v[16:31], v[80:83], v[100:103], 0
    v_exp_f32 v39, v39
    v_exp_f32 v40, v40
    v_exp_f32 v41, v41
    v_exp_f32 v42, v42
    v_exp_f32 v43, v43
    v_smfmac_f32_32x32x32_bf16 v[64:79], v[84:87], v[32:39], v5
    v_exp_f32 v44, v44
    v_exp_f32 v45, v45
    v_exp_f32 v46, v46
    v_exp_f32 v47, v47
    s_cmp_lt_u32 s6, 4
    s_cbranch_scc1 L_interleave_layers__softmax_full_mha__moe_arch_mod__prompt_pr_86
    s_setprio 0
L_interleave_layers__softmax_full_mha__moe_arch_mod__prompt_pr_86:
    v_exp_f32 v16, v16
    v_exp_f32 v17, v17
    v_smfmac_f32_32x32x32_bf16 v[64:79], v[88:91], v[40:47], v5
    s_mov_b64 exec, s[32:33]
    ds_read_b128 v[84:87], v7 offset:58368
    ds_read_b128 v[88:91], v7 offset:58624
    s_mov_b64 exec, -1
    v_exp_f32 v18, v18
    v_exp_f32 v19, v19
    v_exp_f32 v20, v20
    v_exp_f32 v21, v21
    v_exp_f32 v22, v22
    v_mfma_f32_32x32x16_bf16 v[32:47], v[80:83], v[104:107], 0
    ds_read_b128 v[80:83], v7 offset:57344
    v_exp_f32 v23, v23
    v_exp_f32 v24, v24
    v_exp_f32 v25, v25
    v_exp_f32 v26, v26
    v_exp_f32 v27, v27
    s_waitcnt lgkmcnt(3)
    v_smfmac_f32_32x32x32_bf16 v[48:63], v[92:95], v[16:23], v5
    v_exp_f32 v28, v28
    v_exp_f32 v29, v29
    v_exp_f32 v30, v30
    v_exp_f32 v31, v31
    v_exp_f32 v32, v32
    v_exp_f32 v33, v33
    v_smfmac_f32_32x32x32_bf16 v[48:63], v[96:99], v[24:31], v5
    v_exp_f32 v34, v34
    v_exp_f32 v35, v35
    v_exp_f32 v36, v36
    v_exp_f32 v37, v37
    v_exp_f32 v38, v38
    s_waitcnt lgkmcnt(0)
    v_mfma_f32_32x32x16_bf16 v[16:31], v[80:83], v[100:103], 0
    v_exp_f32 v39, v39
    v_exp_f32 v40, v40
    v_exp_f32 v41, v41
    v_exp_f32 v42, v42
    v_exp_f32 v43, v43
    v_smfmac_f32_32x32x32_bf16 v[64:79], v[92:95], v[32:39], v5
    v_exp_f32 v44, v44
    v_exp_f32 v45, v45
    v_exp_f32 v46, v46
    v_exp_f32 v47, v47
    s_and_b32 s52, s7, s41
    s_cmp_eq_u32 s52, 0
    s_cbranch_scc1 L_interleave_layers__softmax_full_mha__moe_arch_mod__prompt_lt_87
    s_call_b64 s[92:93], L_patchb
L_interleave_layers__softmax_full_mha__moe_arch_mod__prompt_lt_87:
    v_exp_f32 v16, v16
    v_exp_f32 v17, v17
    v_smfmac_f32_32x32x32_bf16 v[64:79], v[96:99], v[40:47], v5
    s_mov_b64 exec, s[32:33]
    ds_read_b128 v[92:95], v7 offset:60416
    ds_read_b128 v[96:99], v7 offset:60672
    s_mov_b64 exec, -1
    v_exp_f32 v18, v18
    v_exp_f32 v19, v19
    v_exp_f32 v20, v20
    v_exp_f32 v21, v21
    v_exp_f32 v22, v22
    v_mfma_f32_32x32x16_bf16 v[32:47], v[80:83], v[104:107], 0
    ds_read_b128 v[80:83], v7 offset:59392
    v_exp_f32 v23, v23
    v_exp_f32 v24, v24
    v_exp_f32 v25, v25
    v_exp_f32 v26, v26
    v_exp_f32 v27, v27
    s_waitcnt lgkmcnt(3)
    v_smfmac_f32_32x32x32_bf16 v[48:63], v[84:87], v[16:23], v5
    v_exp_f32 v28, v28
    v_exp_f32 v29, v29
    v_exp_f32 v30, v30
    v_exp_f32 v31, v31
    v_exp_f32 v32, v32
    v_exp_f32 v33, v33
    v_smfmac_f32_32x32x32_bf16 v[48:63], v[88:91], v[24:31], v5
    v_exp_f32 v34, v34
    v_exp_f32 v35, v35
    v_exp_f32 v36, v36
    v_exp_f32 v37, v37
    v_exp_f32 v38, v38
    s_waitcnt lgkmcnt(0)
    v_mfma_f32_32x32x16_bf16 v[16:31], v[80:83], v[100:103], 0
    v_exp_f32 v39, v39
    v_exp_f32 v40, v40
    v_exp_f32 v41, v41
    v_exp_f32 v42, v42
    v_exp_f32 v43, v43
    v_smfmac_f32_32x32x32_bf16 v[64:79], v[84:87], v[32:39], v5
    v_exp_f32 v44, v44
    v_exp_f32 v45, v45
    v_exp_f32 v46, v46
    v_exp_f32 v47, v47
    s_nop 1
    v_exp_f32 v16, v16
    v_exp_f32 v17, v17
    v_smfmac_f32_32x32x32_bf16 v[64:79], v[88:91], v[40:47], v5
    s_mov_b64 exec, s[32:33]
    ds_read_b128 v[84:87], v7 offset:62464
    ds_read_b128 v[88:91], v7 offset:62720
    s_mov_b64 exec, -1
    v_exp_f32 v18, v18
    v_exp_f32 v19, v19
    v_exp_f32 v20, v20
    v_exp_f32 v21, v21
    v_exp_f32 v22, v22
    v_mfma_f32_32x32x16_bf16 v[32:47], v[80:83], v[104:107], 0
    ds_read_b128 v[80:83], v7 offset:61440
    v_exp_f32 v23, v23
    v_exp_f32 v24, v24
    v_exp_f32 v25, v25
    v_exp_f32 v26, v26
    v_exp_f32 v27, v27
    s_waitcnt lgkmcnt(3)
    v_smfmac_f32_32x32x32_bf16 v[48:63], v[92:95], v[16:23], v5
    v_exp_f32 v28, v28
    v_exp_f32 v29, v29
    v_exp_f32 v30, v30
    v_exp_f32 v31, v31
    v_exp_f32 v32, v32
    v_exp_f32 v33, v33
    v_smfmac_f32_32x32x32_bf16 v[48:63], v[96:99], v[24:31], v5
    v_exp_f32 v34, v34
    v_exp_f32 v35, v35
    v_exp_f32 v36, v36
    v_exp_f32 v37, v37
    v_exp_f32 v38, v38
    s_waitcnt lgkmcnt(0)
    v_mfma_f32_32x32x16_bf16 v[16:31], v[80:83], v[100:103], 0
    v_exp_f32 v39, v39
    v_exp_f32 v40, v40
    v_exp_f32 v41, v41
    v_exp_f32 v42, v42
    v_exp_f32 v43, v43
    v_smfmac_f32_32x32x32_bf16 v[64:79], v[92:95], v[32:39], v5
    v_exp_f32 v44, v44
    v_exp_f32 v45, v45
    v_exp_f32 v46, v46
    v_exp_f32 v47, v47
L_p30:
    s_nop 1
    v_exp_f32 v16, v16
    v_exp_f32 v17, v17
    v_smfmac_f32_32x32x32_bf16 v[64:79], v[96:99], v[40:47], v5
    s_mov_b64 exec, s[32:33]
    ds_read_b128 v[92:95], v7 offset:64512
    ds_read_b128 v[96:99], v7 offset:64768
    s_mov_b64 exec, -1
    v_exp_f32 v18, v18
    v_exp_f32 v19, v19
    v_exp_f32 v20, v20
    v_exp_f32 v21, v21
    v_exp_f32 v22, v22
    v_mfma_f32_32x32x16_bf16 v[32:47], v[80:83], v[104:107], 0
    ds_read_b128 v[80:83], v7 offset:63488
    v_exp_f32 v23, v23
    v_exp_f32 v24, v24
    v_exp_f32 v25, v25
    v_exp_f32 v26, v26
    v_exp_f32 v27, v27
    s_waitcnt lgkmcnt(3)
    v_smfmac_f32_32x32x32_bf16 v[48:63], v[84:87], v[16:23], v5
    s_mul_i32 s52, s6, 2560
    s_add_u32 s52, s52, 139264
    v_add_u32 v12, s52, v4
    v_lshl_add_u32 v13, v1, 3, s52
    s_xor_b32 s53, s6, 1
    s_mul_i32 s52, s53, 2560
    s_add_u32 s52, s52, 139264
    v_add_u32 v14, s52, v4
    v_lshl_add_u32 v15, v1, 3, s52
    s_lshl_b32 s49, s42, 10
    s_lshl_b32 s52, s43, 16
    s_add_u32 s49, s49, s52
    s_add_u32 s49, s49, s36
    s_add_u32 s49, s49, 14680064
    s_and_b32 s50, s4, 7
    s_lshl_b32 s50, s50, 12
    s_lshl_b32 s52, s43, 2
    s_add_u32 s50, s50, s52
    s_lshl_b32 s52, s7, 15
    s_add_u32 s50, s50, s52
    s_add_u32 s50, s50, 21037056
    v_exp_f32 v28, v28
    v_exp_f32 v29, v29
    v_exp_f32 v30, v30
    v_exp_f32 v31, v31
    v_exp_f32 v32, v32
    v_exp_f32 v33, v33
    v_smfmac_f32_32x32x32_bf16 v[48:63], v[88:91], v[24:31], v5
    v_exp_f32 v34, v34
    v_exp_f32 v35, v35
    v_exp_f32 v36, v36
    v_exp_f32 v37, v37
    v_exp_f32 v38, v38
    s_waitcnt lgkmcnt(0)
    v_mfma_f32_32x32x16_bf16 v[16:31], v[80:83], v[100:103], 0
    v_exp_f32 v39, v39
    v_exp_f32 v40, v40
    v_exp_f32 v41, v41
    v_exp_f32 v42, v42
    v_exp_f32 v43, v43
    v_smfmac_f32_32x32x32_bf16 v[64:79], v[84:87], v[32:39], v5
    v_exp_f32 v44, v44
    v_exp_f32 v45, v45
    v_exp_f32 v46, v46
    v_exp_f32 v47, v47
    s_nop 1
    v_exp_f32 v16, v16
    v_exp_f32 v17, v17
    v_smfmac_f32_32x32x32_bf16 v[64:79], v[88:91], v[40:47], v5
    v_exp_f32 v18, v18
    v_exp_f32 v19, v19
    v_exp_f32 v20, v20
    v_exp_f32 v21, v21
    v_exp_f32 v22, v22
    v_mfma_f32_32x32x16_bf16 v[32:47], v[80:83], v[104:107], 0
    v_exp_f32 v23, v23
    v_exp_f32 v24, v24
    v_exp_f32 v25, v25
    v_exp_f32 v26, v26
    v_exp_f32 v27, v27
    s_waitcnt lgkmcnt(0)
    v_smfmac_f32_32x32x32_bf16 v[48:63], v[92:95], v[16:23], v5
    v_exp_f32 v28, v28
    v_exp_f32 v29, v29
    v_exp_f32 v30, v30
    v_exp_f32 v31, v31
    s_nop 0
    v_exp_f32 v32, v32
    v_exp_f32 v33, v33
    v_smfmac_f32_32x32x32_bf16 v[48:63], v[96:99], v[24:31], v5
    v_exp_f32 v34, v34
    v_exp_f32 v35, v35
    v_exp_f32 v36, v36
    v_exp_f32 v37, v37
    v_exp_f32 v38, v38
    v_exp_f32 v39, v39
    v_exp_f32 v40, v40
    v_exp_f32 v41, v41
    v_exp_f32 v42, v42
    v_exp_f32 v43, v43
    v_smfmac_f32_32x32x32_bf16 v[64:79], v[92:95], v[32:39], v5
    v_exp_f32 v44, v44
    v_exp_f32 v45, v45
    v_exp_f32 v46, v46
    v_exp_f32 v47, v47
    s_nop 1
    v_smfmac_f32_32x32x32_bf16 v[64:79], v[96:99], v[40:47], v5
    s_nop 7
    s_nop 3
    s_branch L_interleave_layers__softmax_full_mha__moe_arch_mod__prompt_fin_59
L_interleave_layers__softmax_full_mha__moe_arch_mod__prompt_up_58:
    s_setprio 2
    s_mov_b32 s51, 0
    v_mov_b32 v124, v104
    v_mov_b32 v125, v105
    v_mov_b32 v126, v106
    v_mov_b32 v127, v107
    s_lshl_b32 s45, s41, 16
    s_add_u32 s45, s45, 0
    v_add_u32 v7, s45, v4
    ds_read_b128 v[80:83], v7 offset:0
    v_mov_b32 v128, 0
    v_mov_b32 v129, 0
    v_mov_b32 v130, 0
    v_mov_b32 v131, 0
    v_mov_b32 v132, 0
    v_mov_b32 v133, 0
    v_mov_b32 v134, 0
    v_mov_b32 v135, 0
    v_mov_b32 v136, 0
    v_mov_b32 v40, 0
    v_mov_b32 v41, 0
    v_mov_b32 v42, 0
    v_mov_b32 v43, 0
    v_mov_b32 v44, 0
    v_mov_b32 v45, 0
    v_mov_b32 v46, 0
    v_mov_b32 v47, 0
    s_waitcnt lgkmcnt(0)
    v_mfma_f32_32x32x16_bf16 v[16:31], v[80:83], v[124:127], v[108:123]
    ds_read_b128 v[80:83], v7 offset:2048
    s_mov_b64 exec, s[32:33]
    ds_read_b128 v[84:87], v7 offset:1024
    ds_read_b128 v[88:91], v7 offset:1280
    s_mov_b64 exec, -1
    s_nop 7
    s_add_u32 m0, s49, 16384
    s_add_u32 s55, s50, 16384
    s_and_b32 s54, s55, 0x1c000
    s_and_b32 s55, s55, 0x3fff
    s_lshl_b32 s54, s54, 5
    s_add_u32 s55, s55, s48
    s_add_u32 s55, s55, s54
    buffer_load_dwordx4 v4, s[16:19], s55 offen sc1 lds
    s_add_u32 m0, s49, 81920
    s_add_u32 s55, s50, 81920
    s_and_b32 s54, s55, 0x1c000
    s_and_b32 s55, s55, 0x3fff
    s_lshl_b32 s54, s54, 5
    s_add_u32 s55, s55, s48
    s_add_u32 s55, s55, s54
    buffer_load_dwordx4 v4, s[16:19], s55 offen sc1 lds
    s_add_u32 m0, s49, 24576
    s_add_u32 s55, s50, 24576
    s_and_b32 s54, s55, 0x1c000
    s_and_b32 s55, s55, 0x3fff
    s_lshl_b32 s54, s54, 5
    s_add_u32 s55, s55, s48
    s_add_u32 s55, s55, s54
    buffer_load_dwordx4 v4, s[16:19], s55 offen sc1 lds
    s_add_u32 m0, s49, 90112
    s_add_u32 s55, s50, 90112
    s_and_b32 s54, s55, 0x1c000
    s_and_b32 s55, s55, 0x3fff
    s_lshl_b32 s54, s54, 5
    s_add_u32 s55, s55, s48
    s_add_u32 s55, s55, s54
    buffer_load_dwordx4 v4, s[16:19], s55 offen sc1 lds
    s_mov_b32 s46, 3
    s_call_b64 s[90:91], L_uloop
    s_waitcnt vmcnt(0)
    s_barrier
    s_add_u32 m0, s49, 32768
    s_add_u32 s55, s50, 32768
    s_and_b32 s54, s55, 0x1c000
    s_and_b32 s55, s55, 0x3fff
    s_lshl_b32 s54, s54, 5
    s_add_u32 s55, s55, s48
    s_add_u32 s55, s55, s54
    buffer_load_dwordx4 v4, s[16:19], s55 offen sc1 lds
    s_add_u32 m0, s49, 98304
    s_add_u32 s55, s50, 98304
    s_and_b32 s54, s55, 0x1c000
    s_and_b32 s55, s55, 0x3fff
    s_lshl_b32 s54, s54, 5
    s_add_u32 s55, s55, s48
    s_add_u32 s55, s55, s54
    buffer_load_dwordx4 v4, s[16:19], s55 offen sc1 lds
    s_add_u32 m0, s49, 40960
    s_add_u32 s55, s50, 40960
    s_and_b32 s54, s55, 0x1c000
    s_and_b32 s55, s55, 0x3fff
    s_lshl_b32 s54, s54, 5
    s_add_u32 s55, s55, s48
    s_add_u32 s55, s55, s54
    buffer_load_dwordx4 v4, s[16:19], s55 offen sc1 lds
    s_add_u32 m0, s49, 106496
    s_add_u32 s55, s50, 106496
    s_and_b32 s54, s55, 0x1c000
    s_and_b32 s55, s55, 0x3fff
    s_lshl_b32 s54, s54, 5
    s_add_u32 s55, s55, s48
    s_add_u32 s55, s55, s54
    buffer_load_dwordx4 v4, s[16:19], s55 offen sc1 lds
    s_add_u32 m0, s49, 49152
    s_add_u32 s55, s50, 49152
    s_and_b32 s54, s55, 0x1c000
    s_and_b32 s55, s55, 0x3fff
    s_lshl_b32 s54, s54, 5
    s_add_u32 s55, s55, s48
    s_add_u32 s55, s55, s54
    buffer_load_dwordx4 v4, s[16:19], s55 offen sc1 lds
    s_add_u32 m0, s49, 114688
    s_add_u32 s55, s50, 114688
    s_and_b32 s54, s55, 0x1c000
    s_and_b32 s55, s55, 0x3fff
    s_lshl_b32 s54, s54, 5
    s_add_u32 s55, s55, s48
    s_add_u32 s55, s55, s54
    buffer_load_dwordx4 v4, s[16:19], s55 offen sc1 lds
    s_add_u32 m0, s49, 57344
    s_add_u32 s55, s50, 57344
    s_and_b32 s54, s55, 0x1c000
    s_and_b32 s55, s55, 0x3fff
    s_lshl_b32 s54, s54, 5
    s_add_u32 s55, s55, s48
    s_add_u32 s55, s55, s54
    buffer_load_dwordx4 v4, s[16:19], s55 offen sc1 lds
    s_add_u32 m0, s49, 122880
    s_add_u32 s55, s50, 122880
    s_and_b32 s54, s55, 0x1c000
    s_and_b32 s55, s55, 0x3fff
    s_lshl_b32 s54, s54, 5
    s_add_u32 s55, s55, s48
    s_add_u32 s55, s55, s54
    buffer_load_dwordx4 v4, s[16:19], s55 offen sc1 lds
    s_mov_b32 s46, 1
    s_call_b64 s[90:91], L_uloop
    s_cmp_lg_u32 s88, 2
    s_cbranch_scc1 L_interleave_layers__softmax_full_mha__moe_arch_mod__prompt_ro_88
    s_call_b64 s[92:93], L_s2a
L_interleave_layers__softmax_full_mha__moe_arch_mod__prompt_ro_88:
    s_mov_b32 s46, 2
    s_call_b64 s[90:91], L_uloop
    s_waitcnt vmcnt(0)
    s_cmp_lg_u32 s88, 2
    s_cbranch_scc1 L_interleave_layers__softmax_full_mha__moe_arch_mod__prompt_ro_89
    s_call_b64 s[92:93], L_s2b
L_interleave_layers__softmax_full_mha__moe_arch_mod__prompt_ro_89:
    s_barrier
    s_cmp_lg_u32 s88, 2
    s_cbranch_scc1 L_interleave_layers__softmax_full_mha__moe_arch_mod__prompt_ro_90
    s_call_b64 s[92:93], L_s2c
L_interleave_layers__softmax_full_mha__moe_arch_mod__prompt_ro_90:
    s_setprio 2
    s_mov_b32 s46, 4
    s_call_b64 s[90:91], L_uloop
    s_cmp_lg_u32 s88, 3
    s_cbranch_scc1 L_interleave_layers__softmax_full_mha__moe_arch_mod__prompt_ro_91
    s_call_b64 s[92:93], L_s3a
L_interleave_layers__softmax_full_mha__moe_arch_mod__prompt_ro_91:
    s_mov_b32 s46, 2
    s_call_b64 s[90:91], L_uloop
    s_cmp_lg_u32 s88, 3
    s_cbranch_scc1 L_interleave_layers__softmax_full_mha__moe_arch_mod__prompt_ro_92
    s_waitcnt vmcnt(0)
    s_call_b64 s[92:93], L_s3b
L_interleave_layers__softmax_full_mha__moe_arch_mod__prompt_ro_92:
    s_mov_b32 s46, 2
    s_call_b64 s[90:91], L_uloop
    s_call_b64 s[92:93], L_patcha
    s_mov_b32 s46, 1
    s_call_b64 s[90:91], L_uloop
    v_smfmac_f32_32x32x32_bf16 v[128:143], v[96:99], v[40:47], v5
    s_waitcnt lgkmcnt(0)
    s_nop 7
    s_nop 3
    v_mov_b32 v64, v128
    v_mov_b32 v65, v129
    v_mov_b32 v66, v130
    v_mov_b32 v67, v131
    v_mov_b32 v68, v132
    v_mov_b32 v69, v133
    v_mov_b32 v70, v134
    v_mov_b32 v71, v135
    v_mov_b32 v72, v136
    s_call_b64 s[92:93], L_patchb
    s_setprio 2
    v_mov_b32 v124, v100
    v_mov_b32 v125, v101
    v_mov_b32 v126, v102
    v_mov_b32 v127, v103
    s_lshl_b32 s45, s41, 16
    s_add_u32 s45, s45, 0
    v_add_u32 v7, s45, v4
    ds_read_b128 v[80:83], v7 offset:0
    v_mov_b32 v128, 0
    v_mov_b32 v129, 0
    v_mov_b32 v130, 0
    v_mov_b32 v131, 0
    v_mov_b32 v132, 0
    v_mov_b32 v133, 0
    v_mov_b32 v134, 0
    v_mov_b32 v135, 0
    v_mov_b32 v136, 0
    v_mov_b32 v40, 0
    v_mov_b32 v41, 0
    v_mov_b32 v42, 0
    v_mov_b32 v43, 0
    v_mov_b32 v44, 0
    v_mov_b32 v45, 0
    v_mov_b32 v46, 0
    v_mov_b32 v47, 0
    s_waitcnt lgkmcnt(0)
    v_mfma_f32_32x32x16_bf16 v[16:31], v[80:83], v[124:127], v[108:123]
    ds_read_b128 v[80:83], v7 offset:2048
    s_mov_b64 exec, s[32:33]
    ds_read_b128 v[84:87], v7 offset:1024
    ds_read_b128 v[88:91], v7 offset:1280
    s_mov_b64 exec, -1
    s_nop 7
    s_mov_b32 s46, 15
    s_call_b64 s[90:91], L_uloop
    v_smfmac_f32_32x32x32_bf16 v[128:143], v[96:99], v[40:47], v5
    s_waitcnt lgkmcnt(0)
    s_nop 7
    s_nop 3
    v_mov_b32 v48, v128
    v_mov_b32 v49, v129
    v_mov_b32 v50, v130
    v_mov_b32 v51, v131
    v_mov_b32 v52, v132
    v_mov_b32 v53, v133
    v_mov_b32 v54, v134
    v_mov_b32 v55, v135
    v_mov_b32 v56, v136
    s_cmp_eq_u32 s41, 0
    s_cbranch_scc1 L_interleave_layers__softmax_full_mha__moe_arch_mod__prompt_sw_93
    s_xor_b32 s42, s42, 1
    v_swap_b32 v48, v64
    v_swap_b32 v49, v65
    v_swap_b32 v50, v66
    v_swap_b32 v51, v67
    v_swap_b32 v52, v68
    v_swap_b32 v53, v69
    v_swap_b32 v54, v70
    v_swap_b32 v55, v71
    v_swap_b32 v56, v72
    v_swap_b32 v100, v104
    v_swap_b32 v101, v105
    v_swap_b32 v102, v106
    v_swap_b32 v103, v107
L_interleave_layers__softmax_full_mha__moe_arch_mod__prompt_sw_93:
    s_lshl_b32 s45, s41, 16
    v_add_u32 v7, s45, v4
    ds_read_b128 v[80:83], v7 offset:61440
    s_mov_b64 exec, s[32:33]
    ds_read_b128 v[84:87], v7 offset:62464
    ds_read_b128 v[88:91], v7 offset:62720
    s_mov_b64 exec, -1
    v_mov_b32 v40, 0
    v_mov_b32 v41, 0
    v_mov_b32 v42, 0
    v_mov_b32 v43, 0
    v_mov_b32 v44, 0
    v_mov_b32 v45, 0
    v_mov_b32 v46, 0
    v_mov_b32 v47, 0
    s_waitcnt lgkmcnt(2)
    v_mfma_f32_32x32x16_bf16 v[16:31], v[80:83], v[100:103], 0
    s_setprio 2
    s_nop 7
    s_nop 1
    s_branch L_p30
L_interleave_layers__softmax_full_mha__moe_arch_mod__prompt_fin_59:
    s_waitcnt vmcnt(0)
    ds_write_b128 v12, v[64:67]
    ds_write_b128 v12, v[68:71] offset:1024
    ds_write_b64 v13, v[72:73] offset:2048
    s_mov_b32 s52, 0x17800000
    s_mov_b32 s53, 0x71800000
    v_mul_f32 v10, 0, v48
    v_mul_f32 v11, 0, v64
    v_min_f32 v8, v56, v72
    v_max_f32 v9, v56, v72
    v_fma_f32 v10, v49, 0, v10
    v_fma_f32 v11, v65, 0, v11
    v_fma_f32 v10, v50, 0, v10
    v_fma_f32 v11, v66, 0, v11
    v_fma_f32 v10, v51, 0, v10
    v_fma_f32 v11, v67, 0, v11
    v_fma_f32 v10, v52, 0, v10
    v_fma_f32 v11, v68, 0, v11
    v_fma_f32 v10, v53, 0, v10
    v_fma_f32 v11, v69, 0, v11
    v_fma_f32 v10, v54, 0, v10
    v_fma_f32 v11, v70, 0, v11
    v_fma_f32 v10, v55, 0, v10
    v_fma_f32 v11, v71, 0, v11
    v_fma_f32 v10, v56, 0, v10
    v_fma_f32 v11, v72, 0, v11
    v_cmp_le_f32 s[56:57], s52, v8
    v_cmp_ge_f32 s[58:59], s53, v9
    v_cmp_o_f32 vcc, v10, v11
    s_and_b64 s[56:57], s[56:57], s[58:59]
    s_and_b64 s[56:57], s[56:57], vcc
    s_cmp_eq_u64 s[56:57], -1
    s_cbranch_scc1 L_interleave_layers__softmax_full_mha__moe_arch_mod__prompt_ok_94
    s_call_b64 s[92:93], L_slow
    ds_write_b128 v12, v[64:67]
    ds_write_b128 v12, v[68:71] offset:1024
    ds_write_b64 v13, v[72:73] offset:2048
L_interleave_layers__softmax_full_mha__moe_arch_mod__prompt_ok_94:
    s_waitcnt lgkmcnt(0)
    s_barrier
    ds_read_b64 v[24:25], v15 offset:2048
    ds_read_b128 v[16:19], v14
    ds_read_b128 v[20:23], v14 offset:1024
    s_waitcnt lgkmcnt(2)
    v_or_b32 v10, v57, v25
    v_add_f32 v9, v56, v24
    v_cmp_ne_u32 vcc, 0, v10
    v_rcp_f32 v11, v9
    s_cbranch_vccnz L_interleave_layers__softmax_full_mha__moe_arch_mod__prompt_gen_96
    v_mov_b32 v8, v11
L_interleave_layers__softmax_full_mha__moe_arch_mod__prompt_cj_97:
    v_mul_f32 v48, v48, v11
    v_mul_f32 v49, v49, v11
    v_mul_f32 v50, v50, v11
    v_mul_f32 v51, v51, v11
    v_mul_f32 v52, v52, v11
    v_mul_f32 v53, v53, v11
    v_mul_f32 v54, v54, v11
    v_mul_f32 v55, v55, v11
    s_waitcnt lgkmcnt(1)
    v_fma_f32 v48, v16, v8, v48
    v_fma_f32 v49, v17, v8, v49
    v_fma_f32 v50, v18, v8, v50
    v_fma_f32 v51, v19, v8, v51
    s_waitcnt lgkmcnt(0)
    v_fma_f32 v52, v20, v8, v52
    v_fma_f32 v53, v21, v8, v53
    v_fma_f32 v54, v22, v8, v54
    v_fma_f32 v55, v23, v8, v55
    v_cvt_pk_bf16_f32 v12, v48, v49
    v_cvt_pk_bf16_f32 v13, v50, v51
    v_cvt_pk_bf16_f32 v14, v52, v53
    v_cvt_pk_bf16_f32 v15, v54, v55
    s_setprio 0
    buffer_store_dwordx4 v[12:15], v4, s[16:19], s49 offen sc1
    s_lshl_b32 s51, s6, 9
    v_lshrrev_b32 v2, 3, v1
    v_lshl_add_u32 v6, v2, 6, s51
    v_and_b32 v2, 3, v1
    v_lshl_add_u32 v6, v2, 4, v6
    v_bfe_u32 v2, v1, 2, 1
    v_mul_u32_u24 v2, 32832, v2
    v_add_u32 v6, v2, v6
    s_waitcnt vmcnt(1)
    ds_write_b128 v6, v[224:227] offset:0
    ds_write_b128 v6, v[228:231] offset:4096
    ds_write_b128 v6, v[232:235] offset:8192
    ds_write_b128 v6, v[236:239] offset:12288
    ds_write_b128 v6, v[240:243] offset:16384
    ds_write_b128 v6, v[244:247] offset:20480
    ds_write_b128 v6, v[248:251] offset:24576
    ds_write_b128 v6, v[252:255] offset:28672
    v_mov_b32 v2, s3
    v_lshlrev_b32 v3, 7, v1
    s_waitcnt vmcnt(0) lgkmcnt(0)
    s_barrier
    s_cmp_lg_u32 s6, 0
    s_cbranch_scc1 L_interleave_layers__softmax_full_mha__moe_arch_mod__prompt_fl_98
    s_mov_b64 exec, 0xffffffff
    buffer_store_dword v2, v3, s[16:19], s50 offen sc1
    s_mov_b64 exec, -1
L_interleave_layers__softmax_full_mha__moe_arch_mod__prompt_fl_98:
    s_cmp_lg_u32 s7, 0
    s_cbranch_scc1 L_interleave_layers__softmax_full_mha__moe_arch_mod__prompt_cb_99
    s_call_b64 s[92:93], L_cwbounce
L_interleave_layers__softmax_full_mha__moe_arch_mod__prompt_cb_99:
    s_lshl_b32 s52, s5, 1
    s_lshr_b32 s53, s4, 3
    s_add_u32 s52, s52, s53
    s_lshl_b32 s52, s52, 1
    s_and_b32 s53, s6, 1
    s_add_u32 s52, s52, s53
    s_and_b32 s53, s4, 7
    s_lshl_b32 s53, s53, 2
    s_lshr_b32 s61, s6, 1
    s_add_u32 s53, s53, s61
    s_mov_b32 s40, s52
    s_mov_b32 s41, s53
    s_lshr_b32 s42, s6, 1
    s_lshl_b32 s55, s40, 10
    s_lshl_b32 s56, s42, 19
    s_add_u32 s55, s55, s56
    s_add_u32 s55, s55, s36
    s_add_u32 s55, s55, 14680064
    s_lshl_b32 s56, s42, 13
    v_lshrrev_b32 v2, 5, v1
    v_lshlrev_b32 v2, 2, v2
    v_bfe_u32 v3, v1, 2, 2
    v_add_u32 v2, v2, v3
    v_lshlrev_b32 v2, 6, v2
    v_bfe_u32 v3, v1, 4, 1
    v_lshl_add_u32 v2, v3, 5, v2
    v_and_b32 v3, 3, v1
    v_lshl_add_u32 v2, v3, 3, v2
    v_add_u32 v9, s56, v2
    ds_read_b64_tr_b16 v[80:81], v9 offset:0
    ds_read_b64_tr_b16 v[82:83], v9 offset:512
    ds_read_b64_tr_b16 v[84:85], v9 offset:1024
    ds_read_b64_tr_b16 v[86:87], v9 offset:1536
    ds_read_b64_tr_b16 v[88:89], v9 offset:2048
    ds_read_b64_tr_b16 v[90:91], v9 offset:2560
    ds_read_b64_tr_b16 v[92:93], v9 offset:3072
    ds_read_b64_tr_b16 v[94:95], v9 offset:3584
    ds_read_b64_tr_b16 v[96:97], v9 offset:4096
    ds_read_b64_tr_b16 v[98:99], v9 offset:4608
    ds_read_b64_tr_b16 v[100:101], v9 offset:5120
    ds_read_b64_tr_b16 v[102:103], v9 offset:5632
    ds_read_b64_tr_b16 v[104:105], v9 offset:6144
    ds_read_b64_tr_b16 v[106:107], v9 offset:6656
    ds_read_b64_tr_b16 v[108:109], v9 offset:7168
    ds_read_b64_tr_b16 v[110:111], v9 offset:7680
    ds_read_b64_tr_b16 v[112:113], v9 offset:32832
    ds_read_b64_tr_b16 v[114:115], v9 offset:33344
    ds_read_b64_tr_b16 v[116:117], v9 offset:33856
    ds_read_b64_tr_b16 v[118:119], v9 offset:34368
    ds_read_b64_tr_b16 v[120:121], v9 offset:34880
    ds_read_b64_tr_b16 v[122:123], v9 offset:35392
    ds_read_b64_tr_b16 v[124:125], v9 offset:35904
    ds_read_b64_tr_b16 v[126:127], v9 offset:36416
    ds_read_b64_tr_b16 v[128:129], v9 offset:36928
    ds_read_b64_tr_b16 v[130:131], v9 offset:37440
    ds_read_b64_tr_b16 v[132:133], v9 offset:37952
    ds_read_b64_tr_b16 v[134:135], v9 offset:38464
    ds_read_b64_tr_b16 v[136:137], v9 offset:38976
    ds_read_b64_tr_b16 v[138:139], v9 offset:39488
    ds_read_b64_tr_b16 v[140:141], v9 offset:40000
    ds_read_b64_tr_b16 v[142:143], v9 offset:40512
    v_lshrrev_b32 v2, 5, v1
    s_lshl_b32 s56, s41, 5
    s_add_u32 s56, s56, 162816
    v_lshl_add_u32 v7, v2, 3, s56
    s_lshr_b32 s56, s29, 5
    s_cmp_lg_u32 s56, s40
    s_cbranch_scc1 L_interleave_layers__softmax_full_mha__moe_arch_mod__prompt_ovr_100
    s_cmp_eq_u32 s7, 0
    s_cbranch_scc1 L_interleave_layers__softmax_full_mha__moe_arch_mod__prompt_ovr_100
    v_lshrrev_b32 v2, 5, v1
    v_lshlrev_b32 v10, 5, v2
    s_lshl_b32 s56, s41, 7
    s_add_u32 s56, s56, 1736704
    s_mov_b32 s63, 200000
L_interleave_layers__softmax_full_mha__moe_arch_mod__prompt_poll_101:
    buffer_load_dwordx4 v[168:171], v10, s[16:19], s56 offen offset:0 sc1
    buffer_load_dwordx4 v[172:175], v10, s[16:19], s56 offen offset:16 sc1
    buffer_load_dwordx4 v[176:179], v10, s[16:19], s56 offen offset:64 sc1
    buffer_load_dwordx4 v[180:183], v10, s[16:19], s56 offen offset:80 sc1
    s_waitcnt vmcnt(0)
L_interleave_layers__softmax_full_mha__moe_arch_mod__prompt_pollc_103:
    v_cmp_ne_u32 vcc, s3, v169
    v_cmp_ne_u32 s[60:61], s3, v171
    s_nop 0
    s_or_b64 vcc, vcc, s[60:61]
    v_cmp_ne_u32 s[60:61], s3, v173
    s_nop 0
    s_or_b64 vcc, vcc, s[60:61]
    v_cmp_ne_u32 s[60:61], s3, v175
    s_nop 0
    s_or_b64 vcc, vcc, s[60:61]
    v_cmp_ne_u32 s[60:61], s3, v177
    s_nop 0
    s_or_b64 vcc, vcc, s[60:61]
    v_cmp_ne_u32 s[60:61], s3, v179
    s_nop 0
    s_or_b64 vcc, vcc, s[60:61]
    v_cmp_ne_u32 s[60:61], s3, v181
    s_nop 0
    s_or_b64 vcc, vcc, s[60:61]
    v_cmp_ne_u32 s[60:61], s3, v183
    s_nop 0
    s_or_b64 vcc, vcc, s[60:61]
    s_cbranch_vccz L_interleave_layers__softmax_full_mha__moe_arch_mod__prompt_polld_102
    s_sleep 1
    s_sub_u32 s63, s63, 1
    s_cmp_lg_u32 s63, 0
    s_cbranch_scc1 L_interleave_layers__softmax_full_mha__moe_arch_mod__prompt_poll_101
L_interleave_layers__softmax_full_mha__moe_arch_mod__prompt_polld_102:
    s_and_b32 s56, s29, 31
    v_and_b32 v2, 31, v1
    v_cmp_eq_u32 vcc, s56, v2
    v_lshl_add_u32 v2, v170, 16, v168
    s_nop 0
    v_cndmask_b32 v220, v220, v2, vcc
    v_lshl_add_u32 v2, v174, 16, v172
    v_cndmask_b32 v221, v221, v2, vcc
    v_lshl_add_u32 v2, v178, 16, v176
    v_cndmask_b32 v222, v222, v2, vcc
    v_lshl_add_u32 v2, v182, 16, v180
    v_cndmask_b32 v223, v223, v2, vcc
L_interleave_layers__softmax_full_mha__moe_arch_mod__prompt_ovr_100:
    s_and_b32 s56, s6, 1
    s_mul_i32 s56, s56, 24576
    s_add_u32 s56, s56, 98304
    s_mul_i32 s57, s42, 6144
    s_add_u32 s57, s57, s56
    v_add_u32 v8, s57, v4
    s_sub_u32 s57, s42, 1
    s_and_b32 s57, s57, 3
    s_lshl_b32 s57, s57, 11
    s_add_u32 s57, s57, s56
    v_add_u32 v12, s57, v4
    s_sub_u32 s57, s42, 2
    s_and_b32 s57, s57, 3
    s_lshl_b32 s57, s57, 11
    s_add_u32 s57, s57, s56
    v_add_u32 v13, s57, v4
    s_sub_u32 s57, s42, 3
    s_and_b32 s57, s57, 3
    s_lshl_b32 s57, s57, 11
    s_add_u32 s57, s57, s56
    v_add_u32 v14, s57, v4
    s_sub_u32 s57, s42, 4
    s_and_b32 s57, s57, 3
    s_lshl_b32 s57, s57, 11
    s_add_u32 s57, s57, s56
    v_add_u32 v15, s57, v4
    s_lshl_b32 s85, s40, 12
    s_lshl_b32 s57, s41, 7
    s_add_u32 s85, s85, s57
    s_add_u32 s85, s85, s38
    s_add_u32 s85, s85, 1048576
    s_lshl_b32 s54, s7, 15
    s_add_u32 s54, s54, 21037056
    s_cmp_lg_u32 s6, 0
    s_cbranch_scc1 L_interleave_layers__softmax_full_mha__moe_arch_mod__prompt_wp_104
    s_lshl_b32 s60, s5, 11
    s_lshl_b32 s61, s4, 7
    s_add_u32 s62, s60, s61
    s_add_u32 s62, s62, s54
    v_lshlrev_b32 v2, 2, v1
    s_mov_b64 exec, 0xffffffff
    s_mov_b32 s63, 200000
L_interleave_layers__softmax_full_mha__moe_arch_mod__prompt_poll_105:
    buffer_load_dword v3, v2, s[16:19], s62 offen sc1
    s_waitcnt vmcnt(0)
L_interleave_layers__softmax_full_mha__moe_arch_mod__prompt_pollc_107:
    v_cmp_ne_u32 vcc, s3, v3
    s_cbranch_vccz L_interleave_layers__softmax_full_mha__moe_arch_mod__prompt_polld_106
    s_sleep 1
    s_sub_u32 s63, s63, 1
    s_cmp_lg_u32 s63, 0
    s_cbranch_scc1 L_interleave_layers__softmax_full_mha__moe_arch_mod__prompt_poll_105
L_interleave_layers__softmax_full_mha__moe_arch_mod__prompt_polld_106:
    s_mov_b64 exec, -1
L_interleave_layers__softmax_full_mha__moe_arch_mod__prompt_wp_104:
    s_waitcnt lgkmcnt(0)
    s_barrier
    buffer_load_dwordx4 v[16:19], v4, s[16:19], s55 offen sc1
    s_add_u32 s55, s55, 0x10000
    buffer_load_dwordx4 v[20:23], v4, s[16:19], s55 offen sc1
    s_add_u32 s55, s55, 0x10000
    buffer_load_dwordx4 v[24:27], v4, s[16:19], s55 offen sc1
    s_add_u32 s55, s55, 0x10000
    buffer_load_dwordx4 v[28:31], v4, s[16:19], s55 offen sc1
    s_add_u32 s55, s55, 0x10000
    buffer_load_dwordx4 v[32:35], v4, s[16:19], s55 offen sc1
    s_add_u32 s55, s55, 0x10000
    buffer_load_dwordx4 v[36:39], v4, s[16:19], s55 offen sc1
    s_add_u32 s55, s55, 0x10000
    buffer_load_dwordx4 v[40:43], v4, s[16:19], s55 offen sc1
    s_add_u32 s55, s55, 0x10000
    buffer_load_dwordx4 v[44:47], v4, s[16:19], s55 offen sc1
    s_waitcnt vmcnt(7)
    v_mfma_f32_32x32x16_bf16 v[48:63], v[80:83], v[16:19], 0
    v_mfma_f32_32x32x16_bf16 v[64:79], v[112:115], v[16:19], 0
    s_waitcnt vmcnt(6)
    v_mfma_f32_32x32x16_bf16 v[48:63], v[84:87], v[20:23], v[48:63]
    v_mfma_f32_32x32x16_bf16 v[64:79], v[116:119], v[20:23], v[64:79]
    s_waitcnt vmcnt(5)
    v_mfma_f32_32x32x16_bf16 v[48:63], v[88:91], v[24:27], v[48:63]
    v_mfma_f32_32x32x16_bf16 v[64:79], v[120:123], v[24:27], v[64:79]
    s_waitcnt vmcnt(4)
    v_mfma_f32_32x32x16_bf16 v[48:63], v[92:95], v[28:31], v[48:63]
    v_mfma_f32_32x32x16_bf16 v[64:79], v[124:127], v[28:31], v[64:79]
    s_waitcnt vmcnt(3)
    v_mfma_f32_32x32x16_bf16 v[48:63], v[96:99], v[32:35], v[48:63]
    v_mfma_f32_32x32x16_bf16 v[64:79], v[128:131], v[32:35], v[64:79]
    s_waitcnt vmcnt(2)
    v_mfma_f32_32x32x16_bf16 v[48:63], v[100:103], v[36:39], v[48:63]
    v_mfma_f32_32x32x16_bf16 v[64:79], v[132:135], v[36:39], v[64:79]
    s_waitcnt vmcnt(1)
    v_mfma_f32_32x32x16_bf16 v[48:63], v[104:107], v[40:43], v[48:63]
    v_mfma_f32_32x32x16_bf16 v[64:79], v[136:139], v[40:43], v[64:79]
    s_waitcnt vmcnt(0)
    v_mfma_f32_32x32x16_bf16 v[48:63], v[108:111], v[44:47], v[48:63]
    v_mfma_f32_32x32x16_bf16 v[64:79], v[140:143], v[44:47], v[64:79]
    s_nop 7
    s_nop 1
    s_cmp_eq_u32 s42, 0
    s_cbranch_scc1 L_interleave_layers__softmax_full_mha__moe_arch_mod__prompt_own_108
    ds_write_b128 v12, v[48:51] offset:0
    ds_write_b128 v12, v[52:55] offset:1024
    s_branch L_interleave_layers__softmax_full_mha__moe_arch_mod__prompt_nxt_109
L_interleave_layers__softmax_full_mha__moe_arch_mod__prompt_own_108:
    v_mov_b32 v40, v48
    v_mov_b32 v41, v49
    v_mov_b32 v42, v50
    v_mov_b32 v43, v51
    v_mov_b32 v44, v52
    v_mov_b32 v45, v53
    v_mov_b32 v46, v54
    v_mov_b32 v47, v55
L_interleave_layers__softmax_full_mha__moe_arch_mod__prompt_nxt_109:
    s_cmp_eq_u32 s42, 1
    s_cbranch_scc1 L_interleave_layers__softmax_full_mha__moe_arch_mod__prompt_own_110
    ds_write_b128 v13, v[56:59] offset:6144
    ds_write_b128 v13, v[60:63] offset:7168
    s_branch L_interleave_layers__softmax_full_mha__moe_arch_mod__prompt_nxt_111
L_interleave_layers__softmax_full_mha__moe_arch_mod__prompt_own_110:
    v_mov_b32 v40, v56
    v_mov_b32 v41, v57
    v_mov_b32 v42, v58
    v_mov_b32 v43, v59
    v_mov_b32 v44, v60
    v_mov_b32 v45, v61
    v_mov_b32 v46, v62
    v_mov_b32 v47, v63
L_interleave_layers__softmax_full_mha__moe_arch_mod__prompt_nxt_111:
    s_cmp_eq_u32 s42, 2
    s_cbranch_scc1 L_interleave_layers__softmax_full_mha__moe_arch_mod__prompt_own_112
    ds_write_b128 v14, v[64:67] offset:12288
    ds_write_b128 v14, v[68:71] offset:13312
    s_branch L_interleave_layers__softmax_full_mha__moe_arch_mod__prompt_nxt_113
L_interleave_layers__softmax_full_mha__moe_arch_mod__prompt_own_112:
    v_mov_b32 v40, v64
    v_mov_b32 v41, v65
    v_mov_b32 v42, v66
    v_mov_b32 v43, v67
    v_mov_b32 v44, v68
    v_mov_b32 v45, v69
    v_mov_b32 v46, v70
    v_mov_b32 v47, v71
L_interleave_layers__softmax_full_mha__moe_arch_mod__prompt_nxt_113:
    s_cmp_eq_u32 s42, 3
    s_cbranch_scc1 L_interleave_layers__softmax_full_mha__moe_arch_mod__prompt_own_114
    ds_write_b128 v15, v[72:75] offset:18432
    ds_write_b128 v15, v[76:79] offset:19456
    s_branch L_interleave_layers__softmax_full_mha__moe_arch_mod__prompt_nxt_115
L_interleave_layers__softmax_full_mha__moe_arch_mod__prompt_own_114:
    v_mov_b32 v40, v72
    v_mov_b32 v41, v73
    v_mov_b32 v42, v74
    v_mov_b32 v43, v75
    v_mov_b32 v44, v76
    v_mov_b32 v45, v77
    v_mov_b32 v46, v78
    v_mov_b32 v47, v79
L_interleave_layers__softmax_full_mha__moe_arch_mod__prompt_nxt_115:
    s_waitcnt lgkmcnt(0)
    s_barrier
    ds_read2_b64 v[80:83], v7 offset0:0 offset1:2
    ds_read_b128 v[16:19], v8 offset:0
    ds_read_b128 v[20:23], v8 offset:1024
    ds_read_b128 v[24:27], v8 offset:2048
    ds_read_b128 v[28:31], v8 offset:3072
    ds_read_b128 v[32:35], v8 offset:4096
    ds_read_b128 v[36:39], v8 offset:5120
    v_mov_b32 v12, 0
    v_mov_b32 v13, 0
    v_mov_b32 v14, 0
    s_lshl_b32 s54, s40, 15
    s_lshl_b32 s55, s41, 10
    s_add_u32 s54, s54, s55
    s_add_u32 s54, s54, 18874368
    s_and_b32 s55, s6, 1
    s_lshl_b32 s55, s55, 11
    s_lshl_b32 s56, s42, 4
    s_add_u32 s55, s55, s56
    s_add_u32 s55, s55, 147456
    v_and_b32 v11, 31, v1
    v_lshl_add_u32 v10, v11, 6, s55
    s_waitcnt lgkmcnt(2)
    v_add_f32 v16, v16, v24
    v_add_f32 v17, v17, v25
    v_add_f32 v18, v18, v26
    v_add_f32 v19, v19, v27
    v_add_f32 v20, v20, v28
    v_add_f32 v21, v21, v29
    v_add_f32 v22, v22, v30
    v_add_f32 v23, v23, v31
    s_waitcnt lgkmcnt(0)
    v_add_f32 v32, v32, v40
    v_add_f32 v33, v33, v41
    v_add_f32 v34, v34, v42
    v_add_f32 v35, v35, v43
    v_add_f32 v36, v36, v44
    v_add_f32 v37, v37, v45
    v_add_f32 v38, v38, v46
    v_add_f32 v39, v39, v47
    v_add_f32 v16, v16, v32
    v_add_f32 v17, v17, v33
    v_add_f32 v18, v18, v34
    v_add_f32 v19, v19, v35
    v_add_f32 v20, v20, v36
    v_add_f32 v21, v21, v37
    v_add_f32 v22, v22, v38
    v_add_f32 v23, v23, v39
    v_cvt_pk_bf16_f32 v24, v16, v17
    v_cvt_pk_bf16_f32 v25, v18, v19
    v_cvt_pk_bf16_f32 v26, v20, v21
    v_cvt_pk_bf16_f32 v27, v22, v23
    v_lshlrev_b32 v28, 16, v24
    v_and_b32 v29, 0xffff0000, v24
    v_lshlrev_b32 v30, 16, v220
    v_and_b32 v31, 0xffff0000, v220
    v_add_f32 v28, v28, v30
    v_add_f32 v29, v29, v31
    v_cvt_pk_bf16_f32 v220, v28, v29
    v_lshlrev_b32 v28, 16, v25
    v_and_b32 v29, 0xffff0000, v25
    v_lshlrev_b32 v30, 16, v221
    v_and_b32 v31, 0xffff0000, v221
    v_add_f32 v28, v28, v30
    v_add_f32 v29, v29, v31
    v_cvt_pk_bf16_f32 v221, v28, v29
    v_lshlrev_b32 v28, 16, v26
    v_and_b32 v29, 0xffff0000, v26
    v_lshlrev_b32 v30, 16, v222
    v_and_b32 v31, 0xffff0000, v222
    v_add_f32 v28, v28, v30
    v_add_f32 v29, v29, v31
    v_cvt_pk_bf16_f32 v222, v28, v29
    v_lshlrev_b32 v28, 16, v27
    v_and_b32 v29, 0xffff0000, v27
    v_lshlrev_b32 v30, 16, v223
    v_and_b32 v31, 0xffff0000, v223
    v_add_f32 v28, v28, v30
    v_add_f32 v29, v29, v31
    v_cvt_pk_bf16_f32 v223, v28, v29
    s_cmp_lg_u32 s7, 0
    s_cbranch_scc1 L_interleave_layers__softmax_full_mha__moe_arch_mod__prompt_wq_116
    buffer_store_dwordx4 v[220:223], v4, s[16:19], s54 offen sc1
L_interleave_layers__softmax_full_mha__moe_arch_mod__prompt_wq_116:
    v_dot2c_f32_bf16 v12, s34, v220
    v_dot2c_f32_bf16 v13, v220, v220
    v_dot2c_f32_bf16 v14, v220, v80
    v_dot2c_f32_bf16 v12, s34, v221
    v_dot2c_f32_bf16 v13, v221, v221
    v_dot2c_f32_bf16 v14, v221, v81
    v_dot2c_f32_bf16 v12, s34, v222
    v_dot2c_f32_bf16 v13, v222, v222
    v_dot2c_f32_bf16 v14, v222, v82
    v_dot2c_f32_bf16 v12, s34, v223
    v_dot2c_f32_bf16 v13, v223, v223
    v_dot2c_f32_bf16 v14, v223, v83
    s_nop 0
    v_mov_b32 v16, v12
    v_mov_b32 v17, v13
    v_mov_b32 v18, v14
    v_permlane32_swap_b32 v12, v16
    v_permlane32_swap_b32 v13, v17
    v_permlane32_swap_b32 v14, v18
    v_add_f32 v12, v12, v16
    v_add_f32 v13, v13, v17
    v_add_f32 v14, v14, v18
    ds_write_b128 v10, v[12:15]
    s_waitcnt vmcnt(0) lgkmcnt(0)
    s_barrier
    s_cmp_lg_u32 s6, 7
    s_cbranch_scc1 L_interleave_layers__softmax_full_mha__moe_arch_mod__prompt_pub_117
    v_lshlrev_b32 v2, 6, v1
    v_add_u32 v2, 147456, v2
    ds_read_b128 v[16:19], v2
    ds_read_b128 v[20:23], v2 offset:16
    ds_read_b128 v[24:27], v2 offset:32
    ds_read_b128 v[28:31], v2 offset:48
    s_lshl_b32 s54, s84, 13
    s_and_b32 s55, s4, 7
    s_lshl_b32 s55, s55, 10
    s_add_u32 s54, s54, s55
    s_add_u32 s54, s54, s38
    s_add_u32 s54, s54, 22020096
    v_mov_b32 v15, s3
    s_waitcnt lgkmcnt(0)
    v_add_f32 v16, v16, v20
    v_add_f32 v24, v24, v28
    v_add_f32 v17, v17, v21
    v_add_f32 v25, v25, v29
    v_add_f32 v18, v18, v22
    v_add_f32 v26, v26, v30
    v_add_f32 v12, v16, v24
    v_add_f32 v13, v17, v25
    v_add_f32 v14, v18, v26
    s_cmp_eq_u32 s7, 0
    s_cbranch_scc1 L_interleave_layers__softmax_full_mha__moe_arch_mod__prompt_pub_117_0
    s_add_u32 s55, s54, 0x80000
    buffer_store_dwordx4 v[12:15], v4, s[16:19], s55 offen
    buffer_store_dwordx4 v[12:15], v4, s[16:19], s54 offen sc1
    s_branch L_interleave_layers__softmax_full_mha__moe_arch_mod__prompt_pub_117
L_interleave_layers__softmax_full_mha__moe_arch_mod__prompt_pub_117_0:
    buffer_store_dwordx4 v[12:15], v4, s[16:19], s54 offen sc1
    s_lshl_b32 s54, s5, 11
    s_lshl_b32 s55, s4, 2
    s_add_u32 s54, s54, s55
    s_add_u32 s54, s54, 21102592
    v_lshlrev_b32 v3, 7, v1
    s_mov_b64 exec, 0xffff
    buffer_store_dword v15, v3, s[16:19], s54 offen sc1
    s_mov_b64 exec, -1
L_interleave_layers__softmax_full_mha__moe_arch_mod__prompt_pub_117:
    s_cmp_lg_u32 s7, 0
    s_cbranch_scc1 L_tail
    s_lshl_b32 s52, s6, 10
    v_add_u32 v2, s52, v4
    v_add_u32 v3, 0x10000, v2
    ds_write_b128 v2, v[144:147] offset:0
    ds_write_b128 v2, v[148:151] offset:8192
    ds_write_b128 v2, v[152:155] offset:16384
    ds_write_b128 v2, v[156:159] offset:24576
    ds_write_b128 v2, v[160:163] offset:32768
    ds_write_b128 v2, v[164:167] offset:40960
    ds_write_b128 v2, v[168:171] offset:49152
    ds_write_b128 v2, v[172:175] offset:57344
    ds_write_b128 v3, v[176:179] offset:0
    ds_write_b128 v3, v[180:183] offset:8192
    ds_write_b128 v3, v[184:187] offset:16384
    ds_write_b128 v3, v[188:191] offset:24576
    s_mov_b32 s7, 1
    s_call_b64 s[90:91], L_gsetup
    s_lshl_b32 s43, s5, 2
    s_add_u32 s43, s43, s52
    s_lshl_b32 s55, s43, 15
    s_lshl_b32 s56, s53, 14
    s_add_u32 s55, s55, s56
    s_add_u32 s70, s55, 18874368
    v_lshrrev_b32 v5, 5, v1
    v_lshlrev_b32 v5, 12, v5
    v_and_b32 v2, 31, v1
    v_lshl_add_u32 v5, v2, 4, v5
    s_lshr_b32 s86, s43, 1
    s_lshl_b32 s86, s86, 13
    s_and_b32 s61, s43, 1
    s_lshl_b32 s61, s61, 9
    s_add_u32 s86, s86, s61
    s_add_u32 s86, s86, s38
    s_add_u32 s86, s86, 22020096
    s_mov_b32 s36, 2097152
    s_mov_b32 s37, 4194304
    s_mov_b32 s38, 0x40000
    s_cmp_lg_u32 s6, 0
    s_cbranch_scc1 L_interleave_layers__softmax_full_mha__moe_arch_mod__prompt_wp_118
    s_lshl_b32 s60, s5, 11
    s_lshl_b32 s61, s4, 7
    s_add_u32 s62, s60, s61
    s_add_u32 s62, s62, 21102592
    v_lshlrev_b32 v2, 2, v1
    s_mov_b64 exec, 0xffff
    s_mov_b32 s63, 200000
L_interleave_layers__softmax_full_mha__moe_arch_mod__prompt_poll_119:
    buffer_load_dword v3, v2, s[16:19], s62 offen sc1
    s_waitcnt vmcnt(0)
L_interleave_layers__softmax_full_mha__moe_arch_mod__prompt_pollc_121:
    v_cmp_ne_u32 vcc, s3, v3
    s_cbranch_vccz L_interleave_layers__softmax_full_mha__moe_arch_mod__prompt_polld_120
    s_sleep 1
    s_sub_u32 s63, s63, 1
    s_cmp_lg_u32 s63, 0
    s_cbranch_scc1 L_interleave_layers__softmax_full_mha__moe_arch_mod__prompt_poll_119
L_interleave_layers__softmax_full_mha__moe_arch_mod__prompt_polld_120:
    s_mov_b64 exec, -1
L_interleave_layers__softmax_full_mha__moe_arch_mod__prompt_wp_118:
    s_waitcnt lgkmcnt(0)
    s_barrier
    s_cmp_lg_u32 s53, 0
    s_cbranch_scc1 L_interleave_layers__softmax_full_mha__moe_arch_mod__prompt_x_122
    buffer_load_dwordx4 v[176:179], v5, s[16:19], s86 offen offset:0 sc1
    buffer_load_dwordx4 v[180:183], v5, s[16:19], s86 offen offset:1024 sc1
    buffer_load_dwordx4 v[184:187], v5, s[16:19], s86 offen offset:2048 sc1
    buffer_load_dwordx4 v[188:191], v5, s[16:19], s86 offen offset:3072 sc1
L_interleave_layers__softmax_full_mha__moe_arch_mod__prompt_x_122:
    s_add_u32 s56, s71, 0
    s_and_b32 s56, s56, 3
    s_lshl_b32 s56, s56, 12
    s_add_u32 s56, s56, s70
    buffer_load_dwordx4 v[16:19], v4, s[16:19], s56 offen offset:0 sc1
    buffer_load_dwordx4 v[20:23], v4, s[16:19], s56 offen offset:1024 sc1
    buffer_load_dwordx4 v[24:27], v4, s[16:19], s56 offen offset:2048 sc1
    buffer_load_dwordx4 v[28:31], v4, s[16:19], s56 offen offset:3072 sc1
    s_barrier
    s_add_u32 s56, s71, 1
    s_and_b32 s56, s56, 3
    s_lshl_b32 s56, s56, 12
    s_add_u32 s56, s56, s70
    buffer_load_dwordx4 v[32:35], v4, s[16:19], s56 offen offset:0 sc1
    buffer_load_dwordx4 v[36:39], v4, s[16:19], s56 offen offset:1024 sc1
    buffer_load_dwordx4 v[40:43], v4, s[16:19], s56 offen offset:2048 sc1
    buffer_load_dwordx4 v[44:47], v4, s[16:19], s56 offen offset:3072 sc1
    s_branch L_G
L_tail:
    s_mov_b32 s7, 2
    s_cmp_ge_u32 s6, 2
    s_cbranch_scc1 L_tail_b
    s_mov_b32 s43, s40
    v_lshrrev_b32 v5, 5, v1
    v_lshlrev_b32 v5, 12, v5
    v_and_b32 v2, 31, v1
    v_lshl_add_u32 v5, v2, 4, v5
    s_lshr_b32 s86, s43, 1
    s_lshl_b32 s86, s86, 13
    s_and_b32 s61, s43, 1
    s_lshl_b32 s61, s61, 9
    s_add_u32 s86, s86, s61
    s_add_u32 s86, s86, s38
    s_add_u32 s86, s86, 22544384
    buffer_load_dwordx4 v[176:179], v5, s[16:19], s86 offen offset:0 sc1
    buffer_load_dwordx4 v[180:183], v5, s[16:19], s86 offen offset:1024 sc1
    buffer_load_dwordx4 v[184:187], v5, s[16:19], s86 offen offset:2048 sc1
    buffer_load_dwordx4 v[188:191], v5, s[16:19], s86 offen offset:3072 sc1
    s_waitcnt vmcnt(0)
    s_call_b64 s[90:91], L_rowpar
L_tail_b:
    s_barrier
    s_call_b64 s[90:91], L_pub
    v_permlane32_swap_b32 v220, v222
    v_permlane32_swap_b32 v221, v223
    v_lshrrev_b32 v2, 5, v1
    v_lshlrev_b32 v2, 4, v2
    v_and_b32 v3, 31, v1
    v_lshl_add_u32 v2, v3, 10, v2
    s_lshl_b32 s54, s40, 15
    s_lshl_b32 s55, s41, 5
    s_add_u32 s54, s54, s55
    s_andn2_b64 exec, exec, s[48:49]
    buffer_store_dwordx4 v[220:223], v2, s[24:27], s54 offen
    s_mov_b64 exec, -1
    s_cmp_eq_u32 s30, 0
    s_cbranch_scc1 L_end
    s_cmp_eq_u32 s30, 3
    s_cbranch_scc1 L_end
    s_and_b32 s52, s4, 7
    s_cmp_eq_u32 s52, 5
    s_cbranch_scc1 L_end
    s_mov_b32 s62, 1310720
    s_mov_b32 s59, 1720320
    s_cmp_lg_u32 s6, 7
    s_cbranch_scc1 L_tail_k
    s_call_b64 s[90:91], L_getkey
L_tail_k:
    s_waitcnt lgkmcnt(0)
    s_barrier
    s_call_b64 s[90:91], L_getsel
    s_cmp_eq_u32 s30, 2
    s_cbranch_scc1 L_tail2
    s_call_b64 s[92:93], L_s1a
    s_waitcnt vmcnt(0)
    s_call_b64 s[92:93], L_s1b
    s_barrier
    s_call_b64 s[92:93], L_s1c
    s_branch L_end
L_tail2:
    s_cmp_lt_u32 s6, 6
    s_cbranch_scc1 L_tail3
    s_call_b64 s[92:93], L_lose
L_tail3:
    s_call_b64 s[92:93], L_s2a
    s_waitcnt vmcnt(0)
    s_call_b64 s[92:93], L_s2b
    s_barrier
    s_call_b64 s[92:93], L_s2c
    s_branch L_end
L_end:
L_exit:
    s_endpgm
L_interleave_layers__softmax_full_mha__moe_arch_mod__prompt_gen_96:
    v_max_f32 v10, v57, v25
    v_sub_f32 v11, v57, v10
    v_sub_f32 v8, v25, v10
    v_exp_f32 v11, v11
    v_exp_f32 v8, v8
    v_mul_f32 v9, v56, v11
    v_fma_f32 v9, v24, v8, v9
    v_rcp_f32 v10, v9
    s_nop 0
    v_mul_f32 v11, v11, v10
    v_mul_f32 v8, v8, v10
    s_branch L_interleave_layers__softmax_full_mha__moe_arch_mod__prompt_cj_97
L_gsetup:
    s_and_b32 s52, s6, 3
    s_lshr_b32 s53, s6, 2
    s_sub_u32 s54, 3, s7
    s_add_u32 s55, s7, 8
    v_lshrrev_b32 v2, 5, v1
    v_lshlrev_b32 v2, s54, v2
    v_bfe_u32 v3, v1, 2, 2
    v_add_u32 v2, v2, v3
    v_lshlrev_b32 v2, 6, v2
    v_bfe_u32 v3, v1, 4, 1
    v_lshl_add_u32 v2, v3, 5, v2
    v_and_b32 v3, 3, v1
    v_lshl_add_u32 v2, v3, 3, v2
    s_mul_i32 s54, s53, 49152
    s_lshl_b32 s55, 1, s55
    s_or_b32 s87, s7, s53
    s_lshl_b32 s87, s87, 2
    s_add_u32 s87, s87, s52
    s_add_u32 s60, s71, 0
    s_and_b32 s60, s60, 3
    s_lshl_b32 s60, s60, 12
    s_add_u32 s60, s60, s54
    v_add_u32 v8, s60, v2
    s_add_u32 s60, s60, s55
    v_add_u32 v9, s60, v2
    s_add_u32 s60, s71, 1
    s_and_b32 s60, s60, 3
    s_lshl_b32 s60, s60, 12
    s_add_u32 s60, s60, s54
    v_add_u32 v10, s60, v2
    s_add_u32 s60, s60, s55
    v_add_u32 v11, s60, v2
    s_add_u32 s60, s71, 2
    s_and_b32 s60, s60, 3
    s_lshl_b32 s60, s60, 12
    s_add_u32 s60, s60, s54
    v_add_u32 v12, s60, v2
    s_add_u32 s60, s60, s55
    v_add_u32 v13, s60, v2
    s_add_u32 s60, s71, 3
    s_and_b32 s60, s60, 3
    s_lshl_b32 s60, s60, 12
    s_add_u32 s60, s60, s54
    v_add_u32 v14, s60, v2
    s_add_u32 s60, s60, s55
    v_add_u32 v15, s60, v2
    s_setpc_b64 s[90:91]
L_rowpar:
    s_mov_b32 s63, 200000
    s_branch L_interleave_layers__softmax_full_mha__moe_arch_mod__prompt_pollc_125
L_interleave_layers__softmax_full_mha__moe_arch_mod__prompt_poll_123:
    s_andn2_b32 s86, s86, 0x80000
    s_and_b32 s60, s63, 3
    s_cmp_lg_u32 s60, 0
    s_cselect_b32 s60, 0x80000, 0
    s_or_b32 s86, s86, s60
    buffer_load_dwordx4 v[176:179], v5, s[16:19], s86 offen offset:0 sc1
    buffer_load_dwordx4 v[180:183], v5, s[16:19], s86 offen offset:1024 sc1
    buffer_load_dwordx4 v[184:187], v5, s[16:19], s86 offen offset:2048 sc1
    buffer_load_dwordx4 v[188:191], v5, s[16:19], s86 offen offset:3072 sc1
    s_waitcnt vmcnt(0)
L_interleave_layers__softmax_full_mha__moe_arch_mod__prompt_pollc_125:
    v_cmp_ne_u32 vcc, s3, v179
    v_cmp_ne_u32 s[60:61], s3, v183
    s_nop 0
    s_or_b64 vcc, vcc, s[60:61]
    v_cmp_ne_u32 s[60:61], s3, v187
    s_nop 0
    s_or_b64 vcc, vcc, s[60:61]
    v_cmp_ne_u32 s[60:61], s3, v191
    s_nop 0
    s_or_b64 vcc, vcc, s[60:61]
    s_cbranch_vccz L_interleave_layers__softmax_full_mha__moe_arch_mod__prompt_polld_124
    s_sleep 1
    s_sub_u32 s63, s63, 1
    s_cmp_lg_u32 s63, 0
    s_cbranch_scc1 L_interleave_layers__softmax_full_mha__moe_arch_mod__prompt_poll_123
L_interleave_layers__softmax_full_mha__moe_arch_mod__prompt_polld_124:
    v_add_f32 v176, v176, v180
    v_add_f32 v184, v184, v188
    v_add_f32 v177, v177, v181
    v_add_f32 v185, v185, v189
    v_add_f32 v178, v178, v182
    v_add_f32 v186, v186, v190
    v_add_f32 v164, v176, v184
    v_add_f32 v165, v177, v185
    v_add_f32 v166, v178, v186
    v_mov_b32 v180, v164
    v_mov_b32 v181, v165
    v_mov_b32 v182, v166
    v_permlane32_swap_b32 v164, v180
    v_permlane32_swap_b32 v165, v181
    v_permlane32_swap_b32 v166, v182
    v_add_f32 v164, v164, v180
    v_add_f32 v165, v165, v181
    v_add_f32 v166, v166, v182
    v_mul_f32 v164, 0x3b000000, v164
    v_mul_f32 v165, 0x3b000000, v165
    v_fma_f32 v165, -v164, v164, v165
    v_max_f32 v165, 0, v165
    v_cvt_pk_bf16_f32 v167, v164, v165
    v_and_b32 v176, 0xffff0000, v167
    v_lshlrev_b32 v167, 16, v167
    v_add_f32 v176, 925353388, v176
    v_cvt_pk_bf16_f32 v176, v176, v176
    v_and_b32 v176, 0xffff0000, v176
    v_sqrt_f32 v176, v176
    s_nop 0
    v_cvt_pk_bf16_f32 v176, v176, v176
    v_and_b32 v176, 0xffff0000, v176
    v_rcp_f32 v168, v176
    s_and_b32 s54, s43, 3
    s_lshl_b32 s56, s54, 7
    s_add_u32 s56, s56, 152576
    v_and_b32 v177, 31, v1
    v_lshl_add_u32 v169, v177, 2, s56
    v_mov_b32 v176, s28
    v_fma_f32 v166, -v167, v176, v166
    v_mul_f32 v166, v166, v168
    v_cvt_pk_bf16_f32 v166, v166, v166
    ds_write2st64_b32 v169, v167, v168 offset0:4 offset1:6
    v_ashrrev_i32 v176, 31, v166
    v_or_b32 v176, 0x80000000, v176
    v_xor_b32 v166, v166, v176
    v_and_b32 v166, 0xffff0000, v166
    s_lshl_b32 s56, s43, 5
    s_sub_u32 s56, 2047, s56
    v_sub_u32 v176, s56, v177
    v_or_b32 v166, v166, v176
    ds_write_b32 v169, v166 offset:2048
    s_nop 0
    v_max_u32_dpp v166, v166, v166 row_shr:1 row_mask:0xf bank_mask:0xf
    s_nop 1
    v_max_u32_dpp v166, v166, v166 row_shr:2 row_mask:0xf bank_mask:0xf
    s_nop 1
    v_max_u32_dpp v166, v166, v166 row_shr:4 row_mask:0xf bank_mask:0xf
    s_nop 1
    v_max_u32_dpp v166, v166, v166 row_shr:8 row_mask:0xf bank_mask:0xf
    s_nop 1
    v_max_u32_dpp v166, v166, v166 row_bcast:15 row_mask:0xa bank_mask:0xf
    s_nop 1
    v_max_u32_dpp v166, v166, v166 row_bcast:31 row_mask:0xc bank_mask:0xf
    s_and_b32 s54, s43, 3
    s_lshl_b32 s54, s54, 2
    s_add_u32 s54, s54, 155136
    v_mov_b32 v3, s54
    v_mov_b32 v176, v166
    v_mov_b32 v177, s3
    v_mov_b32 v178, 0
    s_lshl_b32 s54, s43, 10
    s_and_b32 s56, s4, 7
    s_lshl_b32 s56, s56, 7
    s_add_u32 s54, s54, s56
    s_lshl_b32 s56, s7, 16
    s_add_u32 s54, s54, s56
    s_add_u32 s54, s54, 1507328
    s_mov_b32 exec_lo, 0
    s_mov_b32 exec_hi, 0x80000000
    buffer_store_dwordx2 v[176:177], v178, s[16:19], s54 offen sc1
    ds_write_b32 v3, v166
    s_mov_b64 exec, -1
    s_waitcnt lgkmcnt(0)
    s_setpc_b64 s[90:91]
L_pub:
    s_and_b32 s54, s40, 3
    s_lshl_b32 s56, s54, 7
    s_add_u32 s56, s56, 152576
    v_and_b32 v3, 31, v1
    v_lshl_add_u32 v2, v3, 2, s56
    ds_read2st64_b32 v[164:165], v2 offset0:4 offset1:6
    ds_read_b32 v186, v2 offset:2048
    s_lshl_b32 s54, s54, 2
    s_add_u32 s54, s54, 155136
    v_mov_b32 v3, s54
    ds_read_b32 v166, v3
    v_mov_b32 v179, s3
    v_mov_b32 v181, v220
    v_mov_b32 v182, v221
    v_mov_b32 v183, s3
    v_mov_b32 v184, v222
    v_mov_b32 v185, v223
    v_mov_b32 v187, s3
    v_lshrrev_b32 v167, 5, v1
    v_mul_u32_u24 v167, 48, v167
    s_waitcnt lgkmcnt(0)
    v_cmp_eq_u32 vcc, v166, v186
    s_nop 0
    s_mov_b64 s[48:49], vcc
    s_mov_b64 exec, vcc
    buffer_store_dwordx4 v[184:187], v167, s[16:19], s85 offen offset:32 sc1
    s_mov_b64 exec, -1
    v_lshlrev_b32 v188, 16, v220
    v_and_b32 v189, 0xffff0000, v220
    v_sub_f32 v188, v188, v164
    v_sub_f32 v189, v189, v164
    v_cvt_pk_bf16_f32 v188, v188, v189
    v_and_b32 v189, 0xffff0000, v188
    v_lshlrev_b32 v188, 16, v188
    v_mul_f32 v188, v188, v165
    v_mul_f32 v189, v189, v165
    v_cvt_pk_bf16_f32 v172, v188, v189
    v_lshlrev_b32 v188, 16, v221
    v_and_b32 v189, 0xffff0000, v221
    v_sub_f32 v188, v188, v164
    v_sub_f32 v189, v189, v164
    v_cvt_pk_bf16_f32 v188, v188, v189
    v_and_b32 v189, 0xffff0000, v188
    v_lshlrev_b32 v188, 16, v188
    v_mul_f32 v188, v188, v165
    v_mul_f32 v189, v189, v165
    v_cvt_pk_bf16_f32 v173, v188, v189
    v_lshlrev_b32 v188, 16, v222
    v_and_b32 v189, 0xffff0000, v222
    v_sub_f32 v188, v188, v164
    v_sub_f32 v189, v189, v164
    v_cvt_pk_bf16_f32 v188, v188, v189
    v_and_b32 v189, 0xffff0000, v188
    v_lshlrev_b32 v188, 16, v188
    v_mul_f32 v188, v188, v165
    v_mul_f32 v189, v189, v165
    v_cvt_pk_bf16_f32 v174, v188, v189
    v_lshlrev_b32 v188, 16, v223
    v_and_b32 v189, 0xffff0000, v223
    v_sub_f32 v188, v188, v164
    v_sub_f32 v189, v189, v164
    v_cvt_pk_bf16_f32 v188, v188, v189
    v_and_b32 v189, 0xffff0000, v188
    v_lshlrev_b32 v188, 16, v188
    v_mul_f32 v188, v188, v165
    v_mul_f32 v189, v189, v165
    v_cvt_pk_bf16_f32 v175, v188, v189
    v_mov_b32 v176, v172
    v_mov_b32 v177, v173
    v_mov_b32 v178, v174
    v_mov_b32 v180, v175
    s_mov_b64 exec, s[48:49]
    buffer_store_dwordx4 v[176:179], v167, s[16:19], s85 offen sc1
    buffer_store_dwordx4 v[180:183], v167, s[16:19], s85 offen offset:16 sc1
    s_mov_b64 exec, -1
    v_lshlrev_b32 v188, 16, v220
    v_and_b32 v189, 0xffff0000, v220
    v_lshlrev_b32 v190, 16, v172
    v_and_b32 v191, 0xffff0000, v172
    v_add_f32 v188, v188, v190
    v_add_f32 v189, v189, v191
    v_cvt_pk_bf16_f32 v220, v188, v189
    v_lshlrev_b32 v188, 16, v221
    v_and_b32 v189, 0xffff0000, v221
    v_lshlrev_b32 v190, 16, v173
    v_and_b32 v191, 0xffff0000, v173
    v_add_f32 v188, v188, v190
    v_add_f32 v189, v189, v191
    v_cvt_pk_bf16_f32 v221, v188, v189
    v_lshlrev_b32 v188, 16, v222
    v_and_b32 v189, 0xffff0000, v222
    v_lshlrev_b32 v190, 16, v174
    v_and_b32 v191, 0xffff0000, v174
    v_add_f32 v188, v188, v190
    v_add_f32 v189, v189, v191
    v_cvt_pk_bf16_f32 v222, v188, v189
    v_lshlrev_b32 v188, 16, v223
    v_and_b32 v189, 0xffff0000, v223
    v_lshlrev_b32 v190, 16, v175
    v_and_b32 v191, 0xffff0000, v175
    v_add_f32 v188, v188, v190
    v_add_f32 v189, v189, v191
    v_cvt_pk_bf16_f32 v223, v188, v189
    s_nop 1
    s_setpc_b64 s[90:91]
L_patcha:
    s_lshl_b32 s89, s43, 9
    s_add_u32 s89, s89, 1744896
    v_lshlrev_b32 v188, 3, v1
    s_mov_b32 exec_hi, 0xffff
    buffer_load_dwordx2 v[176:177], v188, s[16:19], s89 offen sc1
    s_mov_b64 exec, -1
    s_setpc_b64 s[92:93]
L_patchb:
    s_and_b32 s52, s29, 31
    s_and_b32 s56, s52, 0x13
    s_and_b32 s57, s52, 4
    s_lshl_b32 s57, s57, 1
    s_add_u32 s56, s56, s57
    s_and_b32 s57, s52, 8
    s_lshr_b32 s57, s57, 1
    s_add_u32 s56, s56, s57
    s_lshl_b32 s58, s56, 4
    s_add_u32 s58, s58, 129024
    s_bfe_u32 s55, s56, 0x10003
    s_lshl_b32 s55, s55, 9
    s_lshr_b32 s57, s56, 4
    s_lshl_b32 s57, s57, 8
    s_add_u32 s55, s55, s57
    s_and_b32 s57, s56, 7
    s_lshl_b32 s57, s57, 1
    s_add_u32 s55, s55, s57
    s_add_u32 s55, s55, 129536
    v_and_b32 v2, 3, v1
    v_lshlrev_b32 v2, 1, v2
    v_bfe_u32 v3, v1, 3, 1
    v_lshl_add_u32 v2, v3, 3, v2
    v_bfe_u32 v3, v1, 2, 1
    v_lshl_add_u32 v180, v3, 9, v2
    v_add_u32 v180, s58, v180
    v_add_u32 v181, s55, v4
    s_lshl_b32 s53, s6, 5
    s_add_u32 s53, s53, 160768
    v_lshl_add_u32 v182, v3, 4, v2
    v_add_u32 v182, s53, v182
    v_cmp_gt_u32 vcc, 32, v1
    s_nop 1
    v_cndmask_b32 v180, v181, v180, vcc
    v_cmp_gt_u32 vcc, 16, v1
    s_nop 1
    v_cndmask_b32 v180, v180, v182, vcc
    v_lshrrev_b32 v3, 5, v1
    v_lshl_add_u32 v183, v3, 4, s53
    s_mov_b32 s54, -1
    s_mov_b32 s55, 0xffff
    s_waitcnt vmcnt(0)
    s_mov_b64 exec, s[54:55]
    s_mov_b32 s63, 200000
    s_branch L_interleave_layers__softmax_full_mha__moe_arch_mod__prompt_pollc_128
L_interleave_layers__softmax_full_mha__moe_arch_mod__prompt_poll_126:
    buffer_load_dwordx2 v[176:177], v188, s[16:19], s89 offen sc1
    s_waitcnt vmcnt(0)
L_interleave_layers__softmax_full_mha__moe_arch_mod__prompt_pollc_128:
    v_cmp_ne_u32 vcc, s3, v177
    s_cbranch_vccz L_interleave_layers__softmax_full_mha__moe_arch_mod__prompt_polld_127
    s_sleep 1
    s_sub_u32 s63, s63, 1
    s_cmp_lg_u32 s63, 0
    s_cbranch_scc1 L_interleave_layers__softmax_full_mha__moe_arch_mod__prompt_poll_126
L_interleave_layers__softmax_full_mha__moe_arch_mod__prompt_polld_127:
    s_mov_b64 exec, -1
    s_cmp_eq_u32 s41, 0
    s_cselect_b32 exec_lo, 0xffff, -1
    s_cselect_b32 exec_hi, 0, 0xffff
    ds_write_b16 v180, v176
    s_mov_b64 exec, -1
    s_cmp_eq_u32 s40, 0
    s_cbranch_scc1 L_patch_e
    s_lshl_b32 exec_lo, 1, s52
    s_mov_b32 exec_hi, exec_lo
    ds_read_b128 v[100:103], v183
    s_mov_b64 exec, -1
L_patch_e:
    s_waitcnt lgkmcnt(0)
    s_setpc_b64 s[92:93]
    .p2align 6
L_uloop:
    s_setprio 2
    s_add_u32 s51, s51, 1
    s_cmp_lt_u32 s51, 5
    s_cbranch_scc1 L_uloop_h
    s_setprio 0
    s_mov_b32 s51, 0
L_uloop_h:
    v_exp_f32 v16, v16
    v_exp_f32 v17, v17
    v_smfmac_f32_32x32x32_bf16 v[128:143], v[96:99], v[40:47], v5
    s_mov_b64 exec, s[32:33]
    ds_read_b128 v[92:95], v7 offset:3072
    ds_read_b128 v[96:99], v7 offset:3328
    s_mov_b64 exec, -1
    v_exp_f32 v18, v18
    v_exp_f32 v19, v19
    v_exp_f32 v20, v20
    v_exp_f32 v21, v21
    v_exp_f32 v22, v22
    s_waitcnt lgkmcnt(2)
    v_mfma_f32_32x32x16_bf16 v[32:47], v[80:83], v[124:127], v[108:123]
    ds_read_b128 v[80:83], v7 offset:4096
    v_exp_f32 v23, v23
    v_exp_f32 v24, v24
    v_exp_f32 v25, v25
    v_exp_f32 v26, v26
    v_exp_f32 v27, v27
    s_waitcnt lgkmcnt(3)
    v_smfmac_f32_32x32x32_bf16 v[128:143], v[84:87], v[16:23], v5
    v_exp_f32 v28, v28
    v_exp_f32 v29, v29
    v_exp_f32 v30, v30
    v_exp_f32 v31, v31
    v_exp_f32 v32, v32
    v_exp_f32 v33, v33
    v_smfmac_f32_32x32x32_bf16 v[128:143], v[88:91], v[24:31], v5
    s_mov_b64 exec, s[32:33]
    ds_read_b128 v[84:87], v7 offset:5120
    ds_read_b128 v[88:91], v7 offset:5376
    s_mov_b64 exec, -1
    v_exp_f32 v34, v34
    v_exp_f32 v35, v35
    v_exp_f32 v36, v36
    v_exp_f32 v37, v37
    v_exp_f32 v38, v38
    s_waitcnt lgkmcnt(2)
    v_mfma_f32_32x32x16_bf16 v[16:31], v[80:83], v[124:127], v[108:123]
    ds_read_b128 v[80:83], v7 offset:6144
    v_exp_f32 v39, v39
    v_exp_f32 v40, v40
    v_exp_f32 v41, v41
    v_exp_f32 v42, v42
    v_exp_f32 v43, v43
    s_waitcnt lgkmcnt(3)
    v_smfmac_f32_32x32x32_bf16 v[128:143], v[92:95], v[32:39], v5
    v_exp_f32 v44, v44
    v_exp_f32 v45, v45
    v_exp_f32 v46, v46
    v_exp_f32 v47, v47
    v_add_u32 v7, 0x1000, v7
    s_sub_u32 s46, s46, 1
    s_cmp_lg_u32 s46, 0
    s_cbranch_scc1 L_uloop
    s_setpc_b64 s[90:91]
L_slow:
    v_mov_b32 v124, v100
    v_mov_b32 v125, v101
    v_mov_b32 v126, v102
    v_mov_b32 v127, v103
    s_lshl_b32 s45, s41, 16
    v_add_u32 v7, s45, v4
    v_mov_b32 v8, 0xff800000
    s_mov_b32 s46, 32
L_interleave_layers__softmax_full_mha__moe_arch_mod__prompt_mx_129:
    ds_read_b128 v[80:83], v7 offset:0
    s_waitcnt lgkmcnt(0)
    v_mfma_f32_32x32x16_bf16 v[16:31], v[80:83], v[124:127], 0
    v_add_u32 v7, 0x800, v7
    s_nop 10
    v_max3_f32 v8, v16, v17, v8
    v_max3_f32 v8, v18, v19, v8
    v_max3_f32 v8, v20, v21, v8
    v_max3_f32 v8, v22, v23, v8
    v_max3_f32 v8, v24, v25, v8
    v_max3_f32 v8, v26, v27, v8
    v_max3_f32 v8, v28, v29, v8
    v_max3_f32 v8, v30, v31, v8
    s_sub_u32 s46, s46, 1
    s_cmp_lg_u32 s46, 0
    s_cbranch_scc1 L_interleave_layers__softmax_full_mha__moe_arch_mod__prompt_mx_129
    v_mov_b32 v9, v8
    s_nop 1
    v_permlane32_swap_b32 v8, v9
    v_max_f32 v8, v8, v9
    v_sub_f32 v108, 0, v8
    v_sub_f32 v109, 0, v8
    v_sub_f32 v110, 0, v8
    v_sub_f32 v111, 0, v8
    v_sub_f32 v112, 0, v8
    v_sub_f32 v113, 0, v8
    v_sub_f32 v114, 0, v8
    v_sub_f32 v115, 0, v8
    v_sub_f32 v116, 0, v8
    v_sub_f32 v117, 0, v8
    v_sub_f32 v118, 0, v8
    v_sub_f32 v119, 0, v8
    v_sub_f32 v120, 0, v8
    v_sub_f32 v121, 0, v8
    v_sub_f32 v122, 0, v8
    v_sub_f32 v123, 0, v8
    s_lshl_b32 s45, s41, 16
    s_add_u32 s45, s45, 0
    v_add_u32 v7, s45, v4
    ds_read_b128 v[80:83], v7 offset:0
    v_mov_b32 v128, 0
    v_mov_b32 v129, 0
    v_mov_b32 v130, 0
    v_mov_b32 v131, 0
    v_mov_b32 v132, 0
    v_mov_b32 v133, 0
    v_mov_b32 v134, 0
    v_mov_b32 v135, 0
    v_mov_b32 v136, 0
    v_mov_b32 v40, 0
    v_mov_b32 v41, 0
    v_mov_b32 v42, 0
    v_mov_b32 v43, 0
    v_mov_b32 v44, 0
    v_mov_b32 v45, 0
    v_mov_b32 v46, 0
    v_mov_b32 v47, 0
    s_waitcnt lgkmcnt(0)
    v_mfma_f32_32x32x16_bf16 v[16:31], v[80:83], v[124:127], v[108:123]
    ds_read_b128 v[80:83], v7 offset:2048
    s_mov_b64 exec, s[32:33]
    ds_read_b128 v[84:87], v7 offset:1024
    ds_read_b128 v[88:91], v7 offset:1280
    s_mov_b64 exec, -1
    s_nop 7
    s_mov_b32 s46, 16
    s_call_b64 s[90:91], L_uloop
    v_smfmac_f32_32x32x32_bf16 v[128:143], v[96:99], v[40:47], v5
    s_waitcnt lgkmcnt(0)
    s_nop 7
    s_nop 3
    v_mov_b32 v48, v128
    v_mov_b32 v49, v129
    v_mov_b32 v50, v130
    v_mov_b32 v51, v131
    v_mov_b32 v52, v132
    v_mov_b32 v53, v133
    v_mov_b32 v54, v134
    v_mov_b32 v55, v135
    v_mov_b32 v56, v136
    v_mov_b32 v57, v8
    v_mov_b32 v124, v104
    v_mov_b32 v125, v105
    v_mov_b32 v126, v106
    v_mov_b32 v127, v107
    s_lshl_b32 s45, s41, 16
    v_add_u32 v7, s45, v4
    v_mov_b32 v8, 0xff800000
    s_mov_b32 s46, 32
L_interleave_layers__softmax_full_mha__moe_arch_mod__prompt_mx_130:
    ds_read_b128 v[80:83], v7 offset:0
    s_waitcnt lgkmcnt(0)
    v_mfma_f32_32x32x16_bf16 v[16:31], v[80:83], v[124:127], 0
    v_add_u32 v7, 0x800, v7
    s_nop 10
    v_max3_f32 v8, v16, v17, v8
    v_max3_f32 v8, v18, v19, v8
    v_max3_f32 v8, v20, v21, v8
    v_max3_f32 v8, v22, v23, v8
    v_max3_f32 v8, v24, v25, v8
    v_max3_f32 v8, v26, v27, v8
    v_max3_f32 v8, v28, v29, v8
    v_max3_f32 v8, v30, v31, v8
    s_sub_u32 s46, s46, 1
    s_cmp_lg_u32 s46, 0
    s_cbranch_scc1 L_interleave_layers__softmax_full_mha__moe_arch_mod__prompt_mx_130
    v_mov_b32 v9, v8
    s_nop 1
    v_permlane32_swap_b32 v8, v9
    v_max_f32 v8, v8, v9
    v_sub_f32 v108, 0, v8
    v_sub_f32 v109, 0, v8
    v_sub_f32 v110, 0, v8
    v_sub_f32 v111, 0, v8
    v_sub_f32 v112, 0, v8
    v_sub_f32 v113, 0, v8
    v_sub_f32 v114, 0, v8
    v_sub_f32 v115, 0, v8
    v_sub_f32 v116, 0, v8
    v_sub_f32 v117, 0, v8
    v_sub_f32 v118, 0, v8
    v_sub_f32 v119, 0, v8
    v_sub_f32 v120, 0, v8
    v_sub_f32 v121, 0, v8
    v_sub_f32 v122, 0, v8
    v_sub_f32 v123, 0, v8
    s_lshl_b32 s45, s41, 16
    s_add_u32 s45, s45, 0
    v_add_u32 v7, s45, v4
    ds_read_b128 v[80:83], v7 offset:0
    v_mov_b32 v128, 0
    v_mov_b32 v129, 0
    v_mov_b32 v130, 0
    v_mov_b32 v131, 0
    v_mov_b32 v132, 0
    v_mov_b32 v133, 0
    v_mov_b32 v134, 0
    v_mov_b32 v135, 0
    v_mov_b32 v136, 0
    v_mov_b32 v40, 0
    v_mov_b32 v41, 0
    v_mov_b32 v42, 0
    v_mov_b32 v43, 0
    v_mov_b32 v44, 0
    v_mov_b32 v45, 0
    v_mov_b32 v46, 0
    v_mov_b32 v47, 0
    s_waitcnt lgkmcnt(0)
    v_mfma_f32_32x32x16_bf16 v[16:31], v[80:83], v[124:127], v[108:123]
    ds_read_b128 v[80:83], v7 offset:2048
    s_mov_b64 exec, s[32:33]
    ds_read_b128 v[84:87], v7 offset:1024
    ds_read_b128 v[88:91], v7 offset:1280
    s_mov_b64 exec, -1
    s_nop 7
    s_mov_b32 s46, 16
    s_call_b64 s[90:91], L_uloop
    v_smfmac_f32_32x32x32_bf16 v[128:143], v[96:99], v[40:47], v5
    s_waitcnt lgkmcnt(0)
    s_nop 7
    s_nop 3
    v_mov_b32 v64, v128
    v_mov_b32 v65, v129
    v_mov_b32 v66, v130
    v_mov_b32 v67, v131
    v_mov_b32 v68, v132
    v_mov_b32 v69, v133
    v_mov_b32 v70, v134
    v_mov_b32 v71, v135
    v_mov_b32 v72, v136
    v_mov_b32 v73, v8
    s_nop 1
    s_setpc_b64 s[92:93]
L_getkey:
    s_and_b32 s52, s4, 7
    s_lshl_b32 s52, s52, 7
    s_lshl_b32 s53, s7, 16
    s_add_u32 s52, s52, s53
    s_add_u32 s52, s52, 1507328
    v_lshlrev_b32 v6, 10, v1
    s_mov_b32 s63, 200000
L_interleave_layers__softmax_full_mha__moe_arch_mod__prompt_poll_131:
    buffer_load_dwordx2 v[8:9], v6, s[16:19], s52 offen sc1
    s_waitcnt vmcnt(0)
L_interleave_layers__softmax_full_mha__moe_arch_mod__prompt_pollc_133:
    v_cmp_ne_u32 vcc, s3, v9
    s_cbranch_vccz L_interleave_layers__softmax_full_mha__moe_arch_mod__prompt_polld_132
    s_sleep 1
    s_sub_u32 s63, s63, 1
    s_cmp_lg_u32 s63, 0
    s_cbranch_scc1 L_interleave_layers__softmax_full_mha__moe_arch_mod__prompt_poll_131
L_interleave_layers__softmax_full_mha__moe_arch_mod__prompt_polld_132:
    v_max_u32_dpp v8, v8, v8 row_shr:1 row_mask:0xf bank_mask:0xf
    s_nop 1
    v_max_u32_dpp v8, v8, v8 row_shr:2 row_mask:0xf bank_mask:0xf
    s_nop 1
    v_max_u32_dpp v8, v8, v8 row_shr:4 row_mask:0xf bank_mask:0xf
    s_nop 1
    v_max_u32_dpp v8, v8, v8 row_shr:8 row_mask:0xf bank_mask:0xf
    s_nop 1
    v_max_u32_dpp v8, v8, v8 row_bcast:15 row_mask:0xa bank_mask:0xf
    s_nop 1
    v_max_u32_dpp v8, v8, v8 row_bcast:31 row_mask:0xc bank_mask:0xf
    v_mov_b32 v9, 160384
    s_mov_b32 exec_lo, 0
    s_mov_b32 exec_hi, 0x80000000
    ds_write_b32 v9, v8
    s_mov_b64 exec, -1
    s_setpc_b64 s[90:91]
L_getsel:
    v_mov_b32 v9, 160384
    ds_read_b32 v8, v9
    s_waitcnt lgkmcnt(0)
    v_readfirstlane_b32 s52, v8
    s_nop 0
    s_and_b32 s53, s52, 0xffff
    s_sub_u32 s29, 2047, s53
    s_and_b32 s52, s52, 0xffff0000
    s_ashr_i32 s53, s52, 31
    s_not_b32 s53, s53
    s_or_b32 s53, s53, 0x80000000
    s_xor_b32 s52, s52, s53
    s_and_b32 s35, s52, 0xffff0000
    s_setpc_b64 s[90:91]
L_s1a:
    s_lshr_b32 s52, s29, 5
    s_lshl_b32 s52, s52, 12
    s_lshl_b32 s53, s6, 9
    s_add_u32 s52, s52, s53
    s_add_u32 s89, s52, s62
    v_lshrrev_b32 v2, 1, v1
    v_and_b32 v3, 1, v1
    v_mul_u32_u24 v188, 48, v3
    v_lshl_add_u32 v188, v2, 7, v188
    v_mov_b32 v147, 0
    v_mov_b32 v151, 0
    s_mov_b64 exec, 0xff
    buffer_load_dwordx4 v[144:147], v188, s[16:19], s89 offen sc1
    buffer_load_dwordx4 v[148:151], v188, s[16:19], s89 offen offset:16 sc1
    s_mov_b64 exec, -1
    s_setpc_b64 s[92:93]
L_s1b:
    s_lshl_b32 s53, s6, 9
    s_add_u32 s53, s53, 131072
    v_lshrrev_b32 v2, 1, v1
    v_and_b32 v3, 1, v1
    v_lshlrev_b32 v2, 5, v2
    v_lshl_add_u32 v2, v3, 3, v2
    v_add_u32 v11, s53, v2
    v_lshrrev_b32 v2, 4, v1
    v_lshl_add_u32 v12, v2, 3, s53
    s_mov_b64 exec, 0xff
    s_mov_b32 s63, 200000
    s_branch L_interleave_layers__softmax_full_mha__moe_arch_mod__prompt_pollc_136
L_interleave_layers__softmax_full_mha__moe_arch_mod__prompt_poll_134:
    buffer_load_dwordx4 v[144:147], v188, s[16:19], s89 offen sc1
    buffer_load_dwordx4 v[148:151], v188, s[16:19], s89 offen offset:16 sc1
    s_waitcnt vmcnt(0)
L_interleave_layers__softmax_full_mha__moe_arch_mod__prompt_pollc_136:
    v_cmp_ne_u32 vcc, s3, v147
    v_cmp_ne_u32 s[60:61], s3, v151
    s_nop 0
    s_or_b64 vcc, vcc, s[60:61]
    s_cbranch_vccz L_interleave_layers__softmax_full_mha__moe_arch_mod__prompt_polld_135
    s_sleep 1
    s_sub_u32 s63, s63, 1
    s_cmp_lg_u32 s63, 0
    s_cbranch_scc1 L_interleave_layers__softmax_full_mha__moe_arch_mod__prompt_poll_134
L_interleave_layers__softmax_full_mha__moe_arch_mod__prompt_polld_135:
    s_mov_b64 exec, -1
    v_mov_b32 v147, v148
    s_mov_b64 exec, 0xff
    ds_write_b64 v11, v[144:145]
    ds_write_b64 v11, v[146:147] offset:16
    s_mov_b64 exec, -1
    ds_read2_b64 v[152:155], v12 offset0:0 offset1:4
    ds_read2_b64 v[156:159], v12 offset0:8 offset1:12
    s_waitcnt lgkmcnt(0)
    v_mfma_f32_16x16x32_bf16 v[176:179], v[152:155], v[192:195], 0
    v_mfma_f32_16x16x32_bf16 v[180:183], v[152:155], v[196:199], 0
    v_mfma_f32_16x16x32_bf16 v[176:179], v[156:159], v[200:203], v[176:179]
    v_mfma_f32_16x16x32_bf16 v[180:183], v[156:159], v[204:207], v[180:183]
    s_lshl_b32 s52, s6, 2
    s_add_u32 s52, s52, 135168
    v_and_b32 v10, 15, v1
    v_lshl_add_u32 v2, v10, 5, s52
    s_nop 2
    ds_write_b32 v2, v176 offset:0
    ds_write_b32 v2, v180 offset:512
    s_waitcnt lgkmcnt(0)
    s_setpc_b64 s[92:93]
L_s1c:
    s_cmp_lg_u32 s6, 0
    s_cbranch_scc1 L_s1e
    v_and_b32 v10, 15, v1
    v_lshlrev_b32 v3, 5, v10
    v_add_u32 v3, 135168, v3
    ds_read_b128 v[144:147], v3 offset:0
    ds_read_b128 v[148:151], v3 offset:16
    ds_read_b128 v[152:155], v3 offset:512
    ds_read_b128 v[156:159], v3 offset:528
    s_waitcnt lgkmcnt(0)
    v_add_f32 v144, v144, v145
    v_add_f32 v146, v146, v147
    v_add_f32 v148, v148, v149
    v_add_f32 v150, v150, v151
    v_add_f32 v152, v152, v153
    v_add_f32 v154, v154, v155
    v_add_f32 v156, v156, v157
    v_add_f32 v158, v158, v159
    v_add_f32 v144, v144, v146
    v_add_f32 v148, v148, v150
    v_add_f32 v152, v152, v154
    v_add_f32 v156, v156, v158
    v_add_f32 v144, v144, v148
    v_add_f32 v152, v152, v156
    v_cvt_pk_bf16_f32 v144, v144, v144
    v_and_b32 v144, 0xffff0000, v144
    v_cvt_pk_bf16_f32 v152, v152, v152
    v_and_b32 v152, 0xffff0000, v152
    v_mul_f32 v145, 0xbfb8aa3b, v144
    v_exp_f32 v145, v145
    s_nop 0
    v_add_f32 v145, 1.0, v145
    v_rcp_f32 v145, v145
    s_nop 0
    v_mul_f32 v144, v144, v145
    v_cvt_pk_bf16_f32 v144, v144, v144
    v_and_b32 v144, 0xffff0000, v144
    v_mul_f32 v144, v144, v152
    v_cvt_pk_bf16_f32 v144, v144, v144
    v_mov_b32 v145, s3
    v_lshlrev_b32 v2, 3, v1
    s_lshl_b32 s52, s31, 7
    s_add_u32 s52, s52, s59
    s_mov_b64 exec, 0xffff
    buffer_store_dwordx2 v[144:145], v2, s[16:19], s52 offen sc1
    s_mov_b64 exec, -1
L_s1e:
    s_nop 1
    s_setpc_b64 s[92:93]
L_lose:
    s_lshl_b32 s52, s31, 7
    s_add_u32 s52, s52, s62
    s_and_b32 s54, s6, 1
    s_lshl_b32 s54, s54, 17
    s_add_u32 s52, s52, s54
    v_lshrrev_b32 v2, 1, v1
    v_and_b32 v12, 1, v1
    v_mul_u32_u24 v6, 48, v12
    v_lshl_add_u32 v6, v2, 12, v6
    s_mov_b32 s63, 200000
L_interleave_layers__softmax_full_mha__moe_arch_mod__prompt_poll_137:
    buffer_load_dwordx4 v[144:147], v6, s[16:19], s52 offen offset:0 sc1
    buffer_load_dwordx4 v[148:151], v6, s[16:19], s52 offen offset:16 sc1
    buffer_load_dwordx4 v[152:155], v6, s[16:19], s52 offen offset:32 sc1
    s_waitcnt vmcnt(0)
L_interleave_layers__softmax_full_mha__moe_arch_mod__prompt_pollc_139:
    v_cmp_ne_u32 vcc, s3, v147
    v_cmp_ne_u32 s[60:61], s3, v151
    s_nop 0
    s_or_b64 vcc, vcc, s[60:61]
    v_cmp_ne_u32 s[60:61], s3, v155
    s_nop 0
    s_or_b64 vcc, vcc, s[60:61]
    s_cbranch_vccz L_interleave_layers__softmax_full_mha__moe_arch_mod__prompt_polld_138
    s_sleep 1
    s_sub_u32 s63, s63, 1
    s_cmp_lg_u32 s63, 0
    s_cbranch_scc1 L_interleave_layers__softmax_full_mha__moe_arch_mod__prompt_poll_137
L_interleave_layers__softmax_full_mha__moe_arch_mod__prompt_polld_138:
    v_mov_b32 v147, v148
    v_mov_b32 v151, v152
    v_mov_b32 v152, v153
    v_lshlrev_b32 v160, 16, v144
    v_and_b32 v161, 0xffff0000, v144
    v_lshlrev_b32 v162, 16, v149
    v_and_b32 v163, 0xffff0000, v149
    v_add_f32 v160, v160, v162
    v_add_f32 v161, v161, v163
    v_cvt_pk_bf16_f32 v156, v160, v161
    v_lshlrev_b32 v160, 16, v145
    v_and_b32 v161, 0xffff0000, v145
    v_lshlrev_b32 v162, 16, v150
    v_and_b32 v163, 0xffff0000, v150
    v_add_f32 v160, v160, v162
    v_add_f32 v161, v161, v163
    v_cvt_pk_bf16_f32 v157, v160, v161
    v_lshlrev_b32 v160, 16, v146
    v_and_b32 v161, 0xffff0000, v146
    v_lshlrev_b32 v162, 16, v151
    v_and_b32 v163, 0xffff0000, v151
    v_add_f32 v160, v160, v162
    v_add_f32 v161, v161, v163
    v_cvt_pk_bf16_f32 v158, v160, v161
    v_lshlrev_b32 v160, 16, v147
    v_and_b32 v161, 0xffff0000, v147
    v_lshlrev_b32 v162, 16, v152
    v_and_b32 v163, 0xffff0000, v152
    v_add_f32 v160, v160, v162
    v_add_f32 v161, v161, v163
    v_cvt_pk_bf16_f32 v159, v160, v161
    v_and_b32 v2, 0xffff, v154
    v_sub_u32 v2, 2047, v2
    v_cmp_ne_u32 vcc, s29, v2
    v_lshlrev_b32 v2, 10, v2
    v_lshl_add_u32 v2, v12, 3, v2
    s_lshl_b32 s54, s31, 5
    s_mov_b64 exec, vcc
    buffer_store_dwordx2 v[156:157], v2, s[24:27], s54 offen
    buffer_store_dwordx2 v[158:159], v2, s[24:27], s54 offen offset:16
    s_mov_b64 exec, -1
    s_nop 1
    s_setpc_b64 s[92:93]
L_s2a:
    s_lshl_b32 s70, s31, 7
    s_add_u32 s70, s70, s62
    s_lshr_b32 s54, s29, 5
    s_lshl_b32 s54, s54, 12
    s_add_u32 s70, s70, s54
    s_mul_i32 s89, s6, 1792
    s_add_u32 s89, s89, s59
    v_lshlrev_b32 v188, 5, v1
    s_mov_b32 exec_hi, 0x00ffffff
    buffer_load_dwordx4 v[144:147], v188, s[16:19], s89 offen sc1
    buffer_load_dwordx4 v[148:151], v188, s[16:19], s89 offen offset:16 sc1
    s_mov_b64 exec, 0x3f
    buffer_load_dwordx4 v[184:187], v4, s[16:19], s70 offen sc1
    s_mov_b64 exec, -1
    s_setpc_b64 s[92:93]
L_s2b:
    s_lshl_b32 s53, s6, 9
    s_add_u32 s53, s53, 131072
    v_lshl_add_u32 v11, v1, 3, s53
    v_lshrrev_b32 v2, 4, v1
    v_lshl_add_u32 v12, v2, 3, s53
    s_mov_b32 s54, -1
    s_mov_b32 s55, 0x00ffffff
    s_cmp_lg_u32 s6, 0
    s_cbranch_scc1 L_s2b_h
    s_mov_b64 exec, 0x3f
    s_mov_b32 s63, 200000
    s_branch L_interleave_layers__softmax_full_mha__moe_arch_mod__prompt_pollc_142
L_interleave_layers__softmax_full_mha__moe_arch_mod__prompt_poll_140:
    buffer_load_dwordx4 v[184:187], v4, s[16:19], s70 offen sc1
    s_waitcnt vmcnt(0)
L_interleave_layers__softmax_full_mha__moe_arch_mod__prompt_pollc_142:
    v_cmp_ne_u32 vcc, s3, v187
    s_cbranch_vccz L_interleave_layers__softmax_full_mha__moe_arch_mod__prompt_polld_141
    s_sleep 1
    s_sub_u32 s63, s63, 1
    s_cmp_lg_u32 s63, 0
    s_cbranch_scc1 L_interleave_layers__softmax_full_mha__moe_arch_mod__prompt_poll_140
L_interleave_layers__softmax_full_mha__moe_arch_mod__prompt_polld_141:
    s_mov_b64 exec, -1
    v_add_u32 v2, 160256, v4
    s_mov_b64 exec, 0x3f
    ds_write_b128 v2, v[184:187]
    s_mov_b64 exec, -1
L_s2b_h:
    s_mov_b64 exec, s[54:55]
    s_mov_b32 s63, 200000
    s_branch L_interleave_layers__softmax_full_mha__moe_arch_mod__prompt_pollc_145
L_interleave_layers__softmax_full_mha__moe_arch_mod__prompt_poll_143:
    buffer_load_dwordx4 v[144:147], v188, s[16:19], s89 offen sc1
    buffer_load_dwordx4 v[148:151], v188, s[16:19], s89 offen offset:16 sc1
    s_waitcnt vmcnt(0)
L_interleave_layers__softmax_full_mha__moe_arch_mod__prompt_pollc_145:
    v_cmp_ne_u32 vcc, s3, v145
    v_cmp_ne_u32 s[60:61], s3, v147
    s_nop 0
    s_or_b64 vcc, vcc, s[60:61]
    v_cmp_ne_u32 s[60:61], s3, v149
    s_nop 0
    s_or_b64 vcc, vcc, s[60:61]
    v_cmp_ne_u32 s[60:61], s3, v151
    s_nop 0
    s_or_b64 vcc, vcc, s[60:61]
    s_cbranch_vccz L_interleave_layers__softmax_full_mha__moe_arch_mod__prompt_polld_144
    s_sleep 1
    s_sub_u32 s63, s63, 1
    s_cmp_lg_u32 s63, 0
    s_cbranch_scc1 L_interleave_layers__softmax_full_mha__moe_arch_mod__prompt_poll_143
L_interleave_layers__softmax_full_mha__moe_arch_mod__prompt_polld_144:
    s_mov_b64 exec, -1
    v_and_b32 v144, 0xffff, v144
    v_and_b32 v148, 0xffff, v148
    v_lshl_add_u32 v144, v146, 16, v144
    v_lshl_add_u32 v145, v150, 16, v148
    ds_write_b64 v11, v[144:145]
    ds_read2_b64 v[152:155], v12 offset0:0 offset1:4
    ds_read2_b64 v[156:159], v12 offset0:8 offset1:12
    ds_read2_b64 v[160:163], v12 offset0:16 offset1:20
    ds_read2_b64 v[164:167], v12 offset0:24 offset1:28
    ds_read2_b64 v[168:171], v12 offset0:32 offset1:36
    ds_read2_b64 v[172:175], v12 offset0:40 offset1:44
    ds_read2_b64 v[176:179], v12 offset0:48 offset1:52
    s_waitcnt lgkmcnt(6)
    v_mfma_f32_16x16x32_bf16 v[180:183], v[152:155], v[192:195], 0
    s_waitcnt lgkmcnt(5)
    v_mfma_f32_16x16x32_bf16 v[180:183], v[156:159], v[196:199], v[180:183]
    s_waitcnt lgkmcnt(4)
    v_mfma_f32_16x16x32_bf16 v[180:183], v[160:163], v[200:203], v[180:183]
    s_waitcnt lgkmcnt(3)
    v_mfma_f32_16x16x32_bf16 v[180:183], v[164:167], v[204:207], v[180:183]
    s_waitcnt lgkmcnt(2)
    v_mfma_f32_16x16x32_bf16 v[180:183], v[168:171], v[208:211], v[180:183]
    s_waitcnt lgkmcnt(1)
    v_mfma_f32_16x16x32_bf16 v[180:183], v[172:175], v[212:215], v[180:183]
    s_waitcnt lgkmcnt(0)
    v_mfma_f32_16x16x32_bf16 v[180:183], v[176:179], v[216:219], v[180:183]
    s_lshl_b32 s52, s6, 2
    s_add_u32 s52, s52, 135168
    v_and_b32 v10, 15, v1
    v_lshl_add_u32 v2, v10, 5, s52
    s_nop 3
    ds_write_b32 v2, v180 offset:0
    s_waitcnt lgkmcnt(0)
    s_setpc_b64 s[92:93]
L_s2c:
    s_cmp_lg_u32 s6, 0
    s_cbranch_scc1 L_s2e
    v_bfe_u32 v2, v1, 2, 1
    v_mul_u32_u24 v2, 48, v2
    v_and_b32 v3, 1, v1
    v_lshl_add_u32 v2, v3, 1, v2
    v_bfe_u32 v3, v1, 1, 1
    v_lshl_add_u32 v2, v3, 2, v2
    v_bfe_u32 v11, v1, 3, 1
    v_lshl_add_u32 v2, v11, 3, v2
    v_add_u32 v2, 160256, v2
    v_and_b32 v3, v3, v11
    v_lshl_add_u32 v3, v3, 2, v2
    v_lshl_add_u32 v2, v11, 2, v2
    ds_read_u16 v156, v3
    ds_read_u16 v157, v2 offset:20
    v_mov_b32 v158, s35
    v_mul_f32 v159, 0xbfb8aa3b, v158
    v_exp_f32 v159, v159
    s_nop 0
    v_add_f32 v159, 1.0, v159
    v_rcp_f32 v159, v159
    s_nop 0
    v_cvt_pk_bf16_f32 v159, v159, v159
    v_and_b32 v159, 0xffff0000, v159
    s_cmp_lg_u32 s6, 0
    s_cbranch_scc1 L_s2e
    v_and_b32 v10, 15, v1
    v_lshlrev_b32 v3, 5, v10
    v_add_u32 v3, 135168, v3
    ds_read_b128 v[144:147], v3 offset:0
    ds_read_b128 v[148:151], v3 offset:16
    s_waitcnt lgkmcnt(0)
    v_add_f32 v144, v144, v145
    v_add_f32 v146, v146, v147
    v_add_f32 v148, v148, v149
    v_add_f32 v150, v150, v151
    v_add_f32 v144, v144, v146
    v_add_f32 v148, v148, v150
    v_add_f32 v144, v144, v148
    v_cvt_pk_bf16_f32 v144, v144, v144
    v_and_b32 v144, 0xffff0000, v144
    v_mul_f32 v144, v144, v159
    v_cvt_pk_bf16_f32 v144, v144, v144
    v_and_b32 v144, 0xffff0000, v144
    v_lshlrev_b32 v156, 16, v156
    v_lshlrev_b32 v157, 16, v157
    v_add_f32 v144, v144, v156
    v_cvt_pk_bf16_f32 v144, v144, v144
    v_and_b32 v144, 0xffff0000, v144
    v_add_f32 v144, v144, v157
    v_cvt_pk_bf16_f32 v144, v144, v144
    v_and_b32 v144, 0xffff, v144
    v_mov_b32 v145, s3
    s_mov_b64 exec, 0xffff
    s_cmp_eq_u32 s7, 2
    s_cbranch_scc1 L_s2o
    v_lshlrev_b32 v2, 3, v1
    s_lshl_b32 s52, s31, 7
    s_add_u32 s52, s52, 1736704
    buffer_store_dwordx2 v[144:145], v2, s[16:19], s52 offen sc1
    s_branch L_s2x
L_s2o:
    v_lshlrev_b32 v2, 1, v1
    s_lshl_b32 s52, s29, 10
    s_lshl_b32 s53, s31, 5
    s_add_u32 s52, s52, s53
    buffer_store_short v144, v2, s[24:27], s52 offen
L_s2x:
    s_mov_b64 exec, -1
L_s2e:
    s_nop 1
    s_setpc_b64 s[92:93]
L_s3a:
    v_lshlrev_b32 v188, 5, v1
    s_lshl_b32 s89, s6, 9
    s_add_u32 s89, s89, 1736704
    s_mov_b64 exec, 0xffff
    buffer_load_dwordx4 v[144:147], v188, s[16:19], s89 offen sc1
    buffer_load_dwordx4 v[148:151], v188, s[16:19], s89 offen offset:16 sc1
    s_mov_b64 exec, -1
    s_setpc_b64 s[92:93]
L_s3b:
    s_lshl_b32 s53, s6, 9
    s_add_u32 s53, s53, 131072
    v_lshl_add_u32 v11, v1, 3, s53
    v_lshrrev_b32 v2, 4, v1
    v_lshl_add_u32 v12, v2, 3, s53
    v_mov_b32 v160, s34
    v_mov_b32 v161, s34
    v_mov_b32 v162, s34
    v_mov_b32 v163, s34
    s_mov_b64 exec, 0xffff
    s_mov_b32 s63, 200000
    s_branch L_interleave_layers__softmax_full_mha__moe_arch_mod__prompt_pollc_148
L_interleave_layers__softmax_full_mha__moe_arch_mod__prompt_poll_146:
    buffer_load_dwordx4 v[144:147], v188, s[16:19], s89 offen sc1
    buffer_load_dwordx4 v[148:151], v188, s[16:19], s89 offen offset:16 sc1
    s_waitcnt vmcnt(0)
L_interleave_layers__softmax_full_mha__moe_arch_mod__prompt_pollc_148:
    v_cmp_ne_u32 vcc, s3, v145
    v_cmp_ne_u32 s[60:61], s3, v147
    s_nop 0
    s_or_b64 vcc, vcc, s[60:61]
    v_cmp_ne_u32 s[60:61], s3, v149
    s_nop 0
    s_or_b64 vcc, vcc, s[60:61]
    v_cmp_ne_u32 s[60:61], s3, v151
    s_nop 0
    s_or_b64 vcc, vcc, s[60:61]
    s_cbranch_vccz L_interleave_layers__softmax_full_mha__moe_arch_mod__prompt_polld_147
    s_sleep 1
    s_sub_u32 s63, s63, 1
    s_cmp_lg_u32 s63, 0
    s_cbranch_scc1 L_interleave_layers__softmax_full_mha__moe_arch_mod__prompt_poll_146
L_interleave_layers__softmax_full_mha__moe_arch_mod__prompt_polld_147:
    s_mov_b64 exec, -1
    v_lshl_add_u32 v144, v146, 16, v144
    v_lshl_add_u32 v145, v150, 16, v148
    ds_write_b64 v11, v[144:145]
    ds_read2_b64 v[152:155], v12 offset0:0 offset1:4
    ds_read2_b64 v[156:159], v12 offset0:8 offset1:12
    v_mfma_f32_16x16x32_bf16 v[164:167], v[160:163], v[192:195], 0
    v_mfma_f32_16x16x32_bf16 v[168:171], v[160:163], v[196:199], 0
    v_mfma_f32_16x16x32_bf16 v[172:175], v[160:163], v[200:203], 0
    v_mfma_f32_16x16x32_bf16 v[164:167], v[160:163], v[204:207], v[164:167]
    v_mfma_f32_16x16x32_bf16 v[168:171], v[160:163], v[208:211], v[168:171]
    v_mfma_f32_16x16x32_bf16 v[172:175], v[160:163], v[212:215], v[172:175]
    s_waitcnt lgkmcnt(0)
    v_mfma_f32_16x16x32_bf16 v[176:179], v[152:155], v[192:195], 0
    v_mfma_f32_16x16x32_bf16 v[180:183], v[152:155], v[196:199], 0
    v_mfma_f32_16x16x32_bf16 v[184:187], v[152:155], v[200:203], 0
    v_mfma_f32_16x16x32_bf16 v[144:147], v[152:155], v[160:163], 0
    v_mfma_f32_16x16x32_bf16 v[148:151], v[152:155], v[152:155], 0
    v_mfma_f32_16x16x32_bf16 v[176:179], v[156:159], v[204:207], v[176:179]
    v_mfma_f32_16x16x32_bf16 v[180:183], v[156:159], v[208:211], v[180:183]
    v_mfma_f32_16x16x32_bf16 v[184:187], v[156:159], v[212:215], v[184:187]
    v_mfma_f32_16x16x32_bf16 v[144:147], v[156:159], v[160:163], v[144:147]
    v_mfma_f32_16x16x32_bf16 v[148:151], v[156:159], v[156:159], v[148:151]
    s_lshl_b32 s52, s6, 2
    s_add_u32 s52, s52, 135168
    v_and_b32 v10, 15, v1
    v_lshl_add_u32 v2, v10, 5, s52
    v_mov_b32 v3, 161844
    v_mov_b32 v11, 1
    ds_write_b32 v2, v176 offset:0
    ds_write_b32 v2, v180 offset:512
    ds_write_b32 v2, v184 offset:1024
    ds_write_b32 v2, v144 offset:1536
    ds_write_b32 v2, v164 offset:2048
    ds_write_b32 v2, v168 offset:2560
    ds_write_b32 v2, v172 offset:3072
    ds_write_b32 v2, v148 offset:3584
    s_mov_b64 exec, 1
    ds_add_rtn_u32 v11, v3, v11
    s_mov_b64 exec, -1
    v_lshlrev_b32 v3, 5, v1
    v_add_u32 v3, 135168, v3
    s_waitcnt lgkmcnt(0)
    v_readfirstlane_b32 s52, v11
    s_nop 0
    s_cmp_lg_u32 s52, 7
    s_cbranch_scc1 L_s3e
    ds_read_b128 v[144:147], v3
    ds_read_b128 v[148:151], v3 offset:16
    ds_read_b128 v[152:155], v3 offset:2048
    ds_read_b128 v[156:159], v3 offset:2064
    s_waitcnt lgkmcnt(0)
    v_add_f32 v144, v144, v145
    v_add_f32 v146, v146, v147
    v_add_f32 v148, v148, v149
    v_add_f32 v150, v150, v151
    v_add_f32 v152, v152, v153
    v_add_f32 v154, v154, v155
    v_add_f32 v156, v156, v157
    v_add_f32 v158, v158, v159
    v_add_f32 v144, v144, v146
    v_add_f32 v148, v148, v150
    v_add_f32 v152, v152, v154
    v_add_f32 v156, v156, v158
    v_add_f32 v144, v144, v148
    v_add_f32 v152, v152, v156
    v_mov_b32 v160, v144
    v_mov_b32 v161, v152
    v_mul_f32 v160, 0x3b000000, v160
    v_mul_f32 v161, 0x3b000000, v161
    v_fma_f32 v161, -v160, v160, v161
    v_max_f32 v161, 0, v161
    v_cvt_pk_bf16_f32 v162, v160, v161
    v_and_b32 v164, 0xffff0000, v162
    v_lshlrev_b32 v162, 16, v162
    v_add_f32 v164, 925353388, v164
    v_cvt_pk_bf16_f32 v164, v164, v164
    v_and_b32 v164, 0xffff0000, v164
    v_sqrt_f32 v164, v164
    s_nop 0
    v_cvt_pk_bf16_f32 v164, v164, v164
    v_and_b32 v164, 0xffff0000, v164
    v_rcp_f32 v163, v164
    v_readlane_b32 s52, v162, 63
    v_readlane_b32 s53, v163, 63
    v_mov_b32 v146, 1.0
    v_mov_b32 v147, 1052289595
    v_cmp_gt_u32 vcc, 16, v1
    s_nop 1
    v_cndmask_b32 v146, v146, v147, vcc
    v_fma_f32 v144, -s52, v152, v144
    v_mul_f32 v146, s53, v146
    v_mul_f32 v144, v144, v146
    v_cvt_pk_bf16_f32 v144, v144, v144
    v_mov_b32 v145, s3
    v_lshlrev_b32 v2, 3, v1
    s_lshl_b32 s54, s43, 9
    s_add_u32 s54, s54, 1744896
    s_mov_b32 exec_hi, 0xffff
    buffer_store_dwordx2 v[144:145], v2, s[16:19], s54 offen sc1
    s_mov_b64 exec, -1
L_s3e:
    s_nop 1
    s_setpc_b64 s[92:93]
L_cwbounce:
    s_cmp_eq_u32 s30, 0
    s_cbranch_scc1 L_cwbounce_e
    s_xor_b32 s53, s6, 1
    s_mul_i32 s53, s53, 2560
    s_add_u32 s53, s53, 139264
    v_add_u32 v11, s53, v4
    v_lshrrev_b32 v2, 2, v1
    v_lshlrev_b32 v2, 5, v2
    v_and_b32 v3, 3, v1
    v_lshl_add_u32 v2, v3, 3, v2
    v_add_u32 v12, s53, v2
    ds_write_b128 v11, v[192:195] offset:0
    ds_read_b64_tr_b16 v[192:193], v12 offset:0
    ds_read_b64_tr_b16 v[194:195], v12 offset:512
    ds_write_b128 v11, v[196:199] offset:1024
    ds_read_b64_tr_b16 v[196:197], v12 offset:1024
    ds_read_b64_tr_b16 v[198:199], v12 offset:1536
    ds_write_b128 v11, v[200:203] offset:0
    ds_read_b64_tr_b16 v[200:201], v12 offset:0
    ds_read_b64_tr_b16 v[202:203], v12 offset:512
    ds_write_b128 v11, v[204:207] offset:1024
    ds_read_b64_tr_b16 v[204:205], v12 offset:1024
    ds_read_b64_tr_b16 v[206:207], v12 offset:1536
    ds_write_b128 v11, v[208:211] offset:0
    ds_read_b64_tr_b16 v[208:209], v12 offset:0
    ds_read_b64_tr_b16 v[210:211], v12 offset:512
    ds_write_b128 v11, v[212:215] offset:1024
    ds_read_b64_tr_b16 v[212:213], v12 offset:1024
    ds_read_b64_tr_b16 v[214:215], v12 offset:1536
    ds_write_b128 v11, v[216:219] offset:0
    ds_read_b64_tr_b16 v[216:217], v12 offset:0
    ds_read_b64_tr_b16 v[218:219], v12 offset:512
    s_waitcnt lgkmcnt(0)
L_cwbounce_e:
    s_setpc_b64 s[92:93]
.section .rodata,"a"
.p2align 6
.amdhsa_kernel interleave_layers__softmax_full_mha__moe_arch_mod__prompt_kernel
  .amdhsa_next_free_vgpr 256
  .amdhsa_next_free_sgpr 102
  .amdhsa_accum_offset 256
  .amdhsa_group_segment_fixed_size 0
  .amdhsa_kernarg_size 88
  .amdhsa_user_sgpr_count 2
  .amdhsa_user_sgpr_kernarg_segment_ptr 1
  .amdhsa_system_sgpr_workgroup_id_x 1
.end_amdhsa_kernel
```
